```python
import torch

def _softmax(x, axis=-1):
    return torch.softmax(x, dim=axis)

def _gelu(x):
    return torch.nn.functional.gelu(x, approximate='tanh')

def _silu(x):
    return torch.nn.functional.silu(x)

def _sigmoid(x):
    return torch.sigmoid(x)

def _layernorm(x, axis=-1, eps=1e-05):
    m = x.mean(dim=axis, keepdim=True)
    v = x.var(dim=axis, keepdim=True, unbiased=False)
    return (x - m) / torch.sqrt(v + eps)

def _scatter_add(tgt, idx, src, axis=0):
    return tgt.clone().index_add_(axis, idx, src)

def _segment_sum(src, seg, n):
    out = torch.zeros((n,) + src.shape[1:], dtype=src.dtype)
    return out.index_add_(0, seg, src)

def _pad(x, pw):
    flat = tuple((v for pair in reversed(pw) for v in pair))
    return torch.nn.functional.pad(x, flat)
kernel_name = 'standalone__swin_window_attn__vision'

def setup_inputs():

    _w = lambda a: (lambda t: t.to(torch.bfloat16) if t.is_floating_point() else t)(torch.as_tensor(a))
    H = W = 224 // 8 * 8
    C, win = (192, 8)
    return {'x': _w((lambda *s: torch.randn(*s, dtype=torch.bfloat16) * 0.2)(1, H, W, C)), 'wqkv': _w((lambda *s: torch.randn(*s, dtype=torch.bfloat16) * 0.2)(C, 3 * C)), 'wo': _w((lambda *s: torch.randn(*s, dtype=torch.bfloat16) * 0.05)(C, C))}

def reference(x, wqkv, wo):
    B, H, W, C = x.shape
    win = 8
    nh, nw = (H // win, W // win)
    xw = (lambda x, *d: x.permute(*d))(x.reshape(B, nh, win, nw, win, C), 0, 1, 3, 2, 4, 5)
    xw = xw.reshape(B * nh * nw, win * win, C)
    qkv = xw @ wqkv
    q, k, v = (qkv[..., :C].clone(), qkv[..., C:2 * C].clone(), qkv[..., 2 * C:].clone())
    scale = C ** (-0.5)
    p = _softmax(torch.einsum('bqc,bkc->bqk', q, k) * scale, axis=-1)
    o = torch.einsum('bqk,bkc->bqc', p, v) @ wo
    o = (lambda x, *d: x.permute(*d))(o.reshape(B, nh, nw, win, win, C), 0, 1, 3, 2, 4, 5)
    return o.reshape(B, H, W, C)
```

```asm
; @launch grid=(256,1,1) block=(256,1,1) lds=163840
.amdgcn_target "amdgcn-amd-amdhsa--gfx950"
.text
.globl standalone__swin_window_attn__vision_kernel
.p2align 12
.p2align 8
.type standalone__swin_window_attn__vision_kernel,@function
standalone__swin_window_attn__vision_kernel:
  s_load_dwordx4 s[4:7], s[0:1], 0
  s_load_dwordx4 s[40:43], s[0:1], 16
  s_load_dwordx4 s[52:55], s[0:1], 32
  v_lshrrev_b32 v7, 6, v0
  s_cmp_ge_u32 s2, 256
  s_cbranch_scc1 L_end
  v_readfirstlane_b32 s20, v7
  v_and_b32 v8, 63, v0
  v_lshlrev_b32 v3, 4, v8
  s_cmp_lg_u32 s20, 3
  s_cbranch_scc1 L_window
  s_cmp_ge_u32 s2, 72
  s_cbranch_scc1 L_pref
  s_mov_b32 s30, 221184
  s_mov_b32 s31, 0x00020000
  s_mov_b32 s35, 0x00020000
  s_mov_b32 s10, 9216
  s_cmp_ge_u32 s2, 36
  s_cselect_b32 s51, 36, 0
  s_cselect_b64 vcc, -1, 0
  s_cselect_b32 s50, 768, 0
  s_cselect_b32 s21, 64, 36864
  s_cselect_b32 s24, 0, 384
  s_cselect_b32 s25, 18432, s10
  s_cselect_b32 s34, 73728, s30
  s_sub_u32 s51, s2, s51
  s_mul_i32 s48, s51, 43
  s_lshr_b32 s48, s48, 8
  s_mul_i32 s49, s48, 6
  s_sub_u32 s49, s51, s49
  s_mul_i32 s22, s49, 36864
  s_add_u32 s22, s22, s50
  s_mul_i32 s23, s48, s21
  s_add_u32 s23, s23, s24
  v_add_u32 v9, 0, v8
  v_mul_u32_u24 v9, 0xaab, v9
  v_lshrrev_b32 v10, 16, v9
  v_mul_u32_u24 v10, 768, v10
  v_lshrrev_b32 v9, 17, v9
  v_xor_b32 v9, v9, v8
  v_xor_b32 v11, 4, v9
  v_lshl_add_u32 v16, v9, 4, v10
  v_lshl_add_u32 v17, v11, 4, v10
  v_add_u32 v9, 64, v8
  v_mul_u32_u24 v9, 0xaab, v9
  v_lshrrev_b32 v10, 16, v9
  v_mul_u32_u24 v10, 768, v10
  v_lshrrev_b32 v9, 17, v9
  v_xor_b32 v9, v9, v8
  v_xor_b32 v11, 4, v9
  v_lshl_add_u32 v18, v9, 4, v10
  v_lshl_add_u32 v19, v11, 4, v10
  v_add_u32 v9, 128, v8
  v_mul_u32_u24 v9, 0xaab, v9
  v_lshrrev_b32 v10, 16, v9
  v_mul_u32_u24 v10, 768, v10
  v_lshrrev_b32 v9, 17, v9
  v_xor_b32 v9, v9, v8
  v_xor_b32 v11, 4, v9
  v_lshl_add_u32 v20, v9, 4, v10
  v_lshl_add_u32 v21, v11, 4, v10
  v_lshrrev_b32 v14, 2, v8
  v_mul_u32_u24 v14, 384, v14
  v_and_b32 v13, 3, v8
  v_lshl_add_u32 v14, v13, 4, v14
  v_cndmask_b32 v144, v16, v14, vcc
  v_cndmask_b32 v145, v17, v14, vcc
  v_add_u32 v14, 5120, v14
  v_cndmask_b32 v146, v18, v14, vcc
  v_cndmask_b32 v147, v19, v14, vcc
  v_add_u32 v14, 5120, v14
  v_cndmask_b32 v148, v20, v14, vcc
  v_cndmask_b32 v149, v21, v14, vcc
  s_waitcnt lgkmcnt(0)
  s_cmp_ge_u32 s2, 36
  s_mov_b64 s[28:29], s[6:7]
  s_cselect_b64 s[32:33], s[40:41], s[6:7]
  s_mov_b32 m0, 86016
  s_nop 0
  buffer_load_dwordx4 v144, s[32:35], s23 offen offset:0 lds
  buffer_load_dwordx4 v146, s[32:35], s23 offen offset:1024 lds
  buffer_load_dwordx4 v148, s[32:35], s23 offen offset:2048 lds
  s_mov_b32 m0, 89088
  s_add_u32 s23, s23, s25
  buffer_load_dwordx4 v145, s[32:35], s23 offen offset:0 lds
  buffer_load_dwordx4 v147, s[32:35], s23 offen offset:1024 lds
  buffer_load_dwordx4 v149, s[32:35], s23 offen offset:2048 lds
  s_mov_b32 m0, 92160
  s_add_u32 s23, s23, s25
  buffer_load_dwordx4 v144, s[32:35], s23 offen offset:0 lds
  buffer_load_dwordx4 v146, s[32:35], s23 offen offset:1024 lds
  buffer_load_dwordx4 v148, s[32:35], s23 offen offset:2048 lds
  s_mov_b32 m0, 95232
  s_add_u32 s23, s23, s25
  buffer_load_dwordx4 v145, s[32:35], s23 offen offset:0 lds
  buffer_load_dwordx4 v147, s[32:35], s23 offen offset:1024 lds
  buffer_load_dwordx4 v149, s[32:35], s23 offen offset:2048 lds
  s_mov_b32 m0, 73728
  s_nop 0
  buffer_load_dwordx4 v16, s[28:31], s22 offen offset:0 lds
  buffer_load_dwordx4 v18, s[28:31], s22 offen offset:1024 lds
  buffer_load_dwordx4 v20, s[28:31], s22 offen offset:2048 lds
  s_mov_b32 m0, 76800
  s_add_u32 s22, s22, 9216
  buffer_load_dwordx4 v17, s[28:31], s22 offen offset:0 lds
  buffer_load_dwordx4 v19, s[28:31], s22 offen offset:1024 lds
  buffer_load_dwordx4 v21, s[28:31], s22 offen offset:2048 lds
  s_mov_b32 m0, 79872
  s_add_u32 s22, s22, 9216
  buffer_load_dwordx4 v16, s[28:31], s22 offen offset:0 lds
  buffer_load_dwordx4 v18, s[28:31], s22 offen offset:1024 lds
  buffer_load_dwordx4 v20, s[28:31], s22 offen offset:2048 lds
  s_mov_b32 m0, 82944
  s_add_u32 s22, s22, 9216
  buffer_load_dwordx4 v17, s[28:31], s22 offen offset:0 lds
  buffer_load_dwordx4 v19, s[28:31], s22 offen offset:1024 lds
  buffer_load_dwordx4 v21, s[28:31], s22 offen offset:2048 lds
  s_mov_b32 s10, 19267584
  s_mov_b32 s11, 0x00020000
  s_mov_b32 s15, 0x00020000
  s_mov_b32 s18, 0x60000
  s_mov_b32 s19, 0x00020000
  s_mov_b32 s38, 256
  s_mov_b32 s39, 0x00020000
  s_mov_b32 s74, 19267584
  s_mov_b32 s75, 0x00020000
  s_mov_b32 s93, 262144
  s_mov_b32 s94, 263296
  s_mov_b32 s92, 0
  s_mov_b64 s[8:9], s[4:5]
  s_mov_b64 s[16:17], s[54:55]
  s_mov_b64 s[36:37], s[52:53]
  s_mov_b64 s[12:13], s[42:43]
  s_mov_b64 s[72:73], s[42:43]
  s_mov_b32 s95, 327680
  buffer_load_dwordx2 v[6:7], off, s[16:19], s95 sc1
  s_barrier
  s_mov_b32 s14, 0
  v_mov_b32 v1, 0
  v_mov_b32 v240, 0
  v_mov_b32 v241, 0
  v_mov_b32 v242, 0
  v_mov_b32 v243, 0
  v_mov_b32 v244, 0
  v_mov_b32 v245, 0
  v_min_u32 v2, 35, v8
  v_lshlrev_b32 v2, 5, v2
  s_lshr_b32 s26, s2, 3
  s_mul_i32 s27, s26, 57
  s_lshr_b32 s27, s27, 9
  s_mul_i32 s27, s27, 9
  s_sub_u32 s26, s26, s27
  s_lshl_b32 s26, s26, 13
  v_lshl_add_u32 v28, v8, 7, s26
  s_mov_b32 s3, 90112
  v_and_b32 v9, 0x13, v8
  v_and_b32 v10, 4, v8
  v_lshl_or_b32 v9, v10, 1, v9
  v_and_b32 v10, 8, v8
  v_lshrrev_b32 v10, 1, v10
  v_or_b32 v9, v9, v10
  v_mul_u32_u24 v10, 384, v9
  v_add_u32 v10, 73728, v10
  v_bfe_u32 v11, v9, 1, 3
  v_lshrrev_b32 v12, 5, v8
  v_xor_b32 v11, v11, v12
  v_xor_b32 v13, 0, v11
  v_lshl_add_u32 v24, v13, 4, v10
  v_xor_b32 v13, 2, v11
  v_lshl_add_u32 v25, v13, 4, v10
  v_xor_b32 v13, 4, v11
  v_lshl_add_u32 v26, v13, 4, v10
  v_xor_b32 v13, 6, v11
  v_lshl_add_u32 v27, v13, 4, v10
  v_and_b32 v9, 3, v8
  v_bfe_u32 v10, v8, 2, 2
  v_lshl_or_b32 v9, v10, 3, v9
  v_bfe_u32 v10, v8, 4, 1
  v_lshl_or_b32 v9, v10, 2, v9
  v_mul_u32_u24 v10, 384, v9
  v_add_u32 v10, 73728, v10
  v_bfe_u32 v11, v9, 1, 3
  v_lshrrev_b32 v12, 5, v8
  v_xor_b32 v11, v11, v12
  v_xor_b32 v13, 0, v11
  v_lshl_add_u32 v150, v13, 4, v10
  v_xor_b32 v13, 2, v11
  v_lshl_add_u32 v151, v13, 4, v10
  v_xor_b32 v13, 4, v11
  v_lshl_add_u32 v152, v13, 4, v10
  v_xor_b32 v13, 6, v11
  v_lshl_add_u32 v153, v13, 4, v10
  v_bfe_u32 v9, v8, 4, 1
  v_mul_u32_u24 v9, 6144, v9
  v_and_b32 v10, 15, v8
  v_lshl_add_u32 v9, v10, 4, v9
  v_lshl_add_u32 v154, v12, 8, v9
  v_lshlrev_b32 v155, 12, v8
  v_bfe_u32 v14, v8, 2, 2
  v_lshl_add_u32 v14, v12, 3, v14
  v_lshlrev_b32 v14, 6, v14
  v_bfe_u32 v13, v8, 4, 1
  v_lshl_add_u32 v14, v13, 3, v14
  v_and_b32 v13, 3, v8
  v_lshl_add_u32 v14, v13, 4, v14
  v_add_u32 v14, 86016, v14
  s_mul_i32 s26, s48, 12288
  s_add_u32 s27, s26, 90112
  s_lshl_b32 s54, s49, 10
  s_cmp_ge_u32 s2, 36
  s_cselect_b32 s26, s26, s27
  s_cselect_b32 s27, 1.0, 0x3dd53b95
  s_add_u32 s26, s26, s54
  s_lshl_b32 s54, s2, 5
  s_add_u32 s54, s54, 262144
  s_waitcnt vmcnt(13)
  s_cbranch_vccnz L_fold_tr
  ds_read_b128 v[80:83], v150 offset:12288
  ds_read_b128 v[84:87], v151 offset:12288
  ds_read_b128 v[88:91], v152 offset:12288
  ds_read_b128 v[92:95], v153 offset:12288
  ds_read_b128 v[96:99], v150 offset:12416
  ds_read_b128 v[100:103], v151 offset:12416
  ds_read_b128 v[104:107], v152 offset:12416
  ds_read_b128 v[108:111], v153 offset:12416
  ds_read_b128 v[112:115], v150 offset:12544
  ds_read_b128 v[116:119], v151 offset:12544
  ds_read_b128 v[120:123], v152 offset:12544
  ds_read_b128 v[124:127], v153 offset:12544
  s_branch L_fold_a
L_fold_tr:
  ds_read_b64_tr_b16 v[80:81], v14 offset:0
  ds_read_b64_tr_b16 v[82:83], v14 offset:256
  ds_read_b64_tr_b16 v[84:85], v14 offset:1024
  ds_read_b64_tr_b16 v[86:87], v14 offset:1280
  ds_read_b64_tr_b16 v[88:89], v14 offset:2048
  ds_read_b64_tr_b16 v[90:91], v14 offset:2304
  ds_read_b64_tr_b16 v[92:93], v14 offset:3072
  ds_read_b64_tr_b16 v[94:95], v14 offset:3328
  ds_read_b64_tr_b16 v[96:97], v14 offset:4096
  ds_read_b64_tr_b16 v[98:99], v14 offset:4352
  ds_read_b64_tr_b16 v[100:101], v14 offset:5120
  ds_read_b64_tr_b16 v[102:103], v14 offset:5376
  ds_read_b64_tr_b16 v[104:105], v14 offset:6144
  ds_read_b64_tr_b16 v[106:107], v14 offset:6400
  s_waitcnt lgkmcnt(0)
  ds_read_b64_tr_b16 v[108:109], v14 offset:7168
  ds_read_b64_tr_b16 v[110:111], v14 offset:7424
  ds_read_b64_tr_b16 v[112:113], v14 offset:8192
  ds_read_b64_tr_b16 v[114:115], v14 offset:8448
  ds_read_b64_tr_b16 v[116:117], v14 offset:9216
  ds_read_b64_tr_b16 v[118:119], v14 offset:9472
  ds_read_b64_tr_b16 v[120:121], v14 offset:10240
  ds_read_b64_tr_b16 v[122:123], v14 offset:10496
  ds_read_b64_tr_b16 v[124:125], v14 offset:11264
  ds_read_b64_tr_b16 v[126:127], v14 offset:11520
L_fold_a:
  s_waitcnt vmcnt(1) lgkmcnt(0)
  ds_read_b128 v[32:35], v24 offset:0
  ds_read_b128 v[36:39], v25 offset:0
  ds_read_b128 v[40:43], v26 offset:0
  ds_read_b128 v[44:47], v27 offset:0
  ds_read_b128 v[48:51], v24 offset:128
  ds_read_b128 v[52:55], v25 offset:128
  ds_read_b128 v[56:59], v26 offset:128
  ds_read_b128 v[60:63], v27 offset:128
  ds_read_b128 v[64:67], v24 offset:256
  ds_read_b128 v[68:71], v25 offset:256
  ds_read_b128 v[72:75], v26 offset:256
  ds_read_b128 v[76:79], v27 offset:256
  s_waitcnt lgkmcnt(11)
  v_mfma_f32_32x32x16_bf16 v[128:143], v[32:35], v[80:83], 0
  s_waitcnt lgkmcnt(10)
  v_mfma_f32_32x32x16_bf16 v[128:143], v[36:39], v[84:87], v[128:143]
  s_waitcnt lgkmcnt(9)
  v_mfma_f32_32x32x16_bf16 v[128:143], v[40:43], v[88:91], v[128:143]
  s_waitcnt lgkmcnt(8)
  v_mfma_f32_32x32x16_bf16 v[128:143], v[44:47], v[92:95], v[128:143]
  s_waitcnt lgkmcnt(7)
  v_mfma_f32_32x32x16_bf16 v[128:143], v[48:51], v[96:99], v[128:143]
  s_waitcnt lgkmcnt(6)
  v_mfma_f32_32x32x16_bf16 v[128:143], v[52:55], v[100:103], v[128:143]
  s_waitcnt lgkmcnt(5)
  v_mfma_f32_32x32x16_bf16 v[128:143], v[56:59], v[104:107], v[128:143]
  s_waitcnt lgkmcnt(4)
  v_mfma_f32_32x32x16_bf16 v[128:143], v[60:63], v[108:111], v[128:143]
  s_waitcnt lgkmcnt(3)
  v_mfma_f32_32x32x16_bf16 v[128:143], v[64:67], v[112:115], v[128:143]
  s_waitcnt lgkmcnt(2)
  v_mfma_f32_32x32x16_bf16 v[128:143], v[68:71], v[116:119], v[128:143]
  s_waitcnt lgkmcnt(1)
  v_mfma_f32_32x32x16_bf16 v[128:143], v[72:75], v[120:123], v[128:143]
  s_waitcnt lgkmcnt(0)
  v_mfma_f32_32x32x16_bf16 v[128:143], v[76:79], v[124:127], v[128:143]
  s_nop 11
  v_mul_f32 v128, s27, v128
  v_mul_f32 v129, s27, v129
  v_cvt_pk_bf16_f32 v32, v128, v129
  v_mul_f32 v130, s27, v130
  v_mul_f32 v131, s27, v131
  v_cvt_pk_bf16_f32 v33, v130, v131
  v_mul_f32 v132, s27, v132
  v_mul_f32 v133, s27, v133
  v_cvt_pk_bf16_f32 v34, v132, v133
  v_mul_f32 v134, s27, v134
  v_mul_f32 v135, s27, v135
  v_cvt_pk_bf16_f32 v35, v134, v135
  buffer_store_dwordx4 v[32:35], v154, s[16:19], s26 offen sc1
  v_mul_f32 v136, s27, v136
  v_mul_f32 v137, s27, v137
  v_cvt_pk_bf16_f32 v36, v136, v137
  v_mul_f32 v138, s27, v138
  v_mul_f32 v139, s27, v139
  v_cvt_pk_bf16_f32 v37, v138, v139
  v_mul_f32 v140, s27, v140
  v_mul_f32 v141, s27, v141
  v_cvt_pk_bf16_f32 v38, v140, v141
  v_mul_f32 v142, s27, v142
  v_mul_f32 v143, s27, v143
  v_cvt_pk_bf16_f32 v39, v142, v143
  buffer_store_dwordx4 v[36:39], v154, s[16:19], s26 offen offset:512 sc1
  s_waitcnt vmcnt(2)
  v_add_co_u32 v6, vcc, 2, v6
  s_nop 1
  v_addc_co_u32 v7, vcc, 0, v7, vcc
  v_or_b32 v6, 1, v6
  s_mov_b64 exec, 1
  s_cmp_lg_u32 s2, 0
  s_cbranch_scc1 L_fold_pub
  buffer_store_dwordx2 v[6:7], off, s[36:39], 0 sc1
L_fold_pub:
  s_waitcnt vmcnt(0)
  s_mov_b64 exec, 1
  buffer_store_dwordx2 v[6:7], v155, s[16:19], s54 offen sc1
  s_mov_b64 exec, -1
  s_cmp_ge_u32 s2, 36
  s_cbranch_scc1 L_noq2
  s_barrier
L_noq2:
  s_branch L_loader
.p2align 6
L_window:
  s_mul_i32 s21, s2, 3
  s_add_u32 s21, s21, s20
  s_mul_hi_u32 s23, s21, 153391690
  s_mul_i32 s24, s23, 28
  s_sub_u32 s24, s21, s24
  s_mul_i32 s23, s23, 688128
  s_mul_i32 s24, s24, 3072
  s_add_u32 s44, s23, s24
  s_add_u32 s46, s44, 344064
  s_mul_i32 s24, s20, 24576
  s_mov_b32 s14, 19267584
  v_add_u32 v9, 0, v8
  v_mul_u32_u24 v9, 0xaab, v9
  v_lshrrev_b32 v9, 17, v9
  v_xor_b32 v9, v9, v8
  v_lshlrev_b32 v240, 4, v9
  v_xor_b32 v241, 64, v240
  v_add_u32 v9, 64, v8
  v_mul_u32_u24 v9, 0xaab, v9
  v_lshrrev_b32 v9, 17, v9
  v_xor_b32 v9, v9, v8
  v_lshlrev_b32 v242, 4, v9
  v_xor_b32 v243, 64, v242
  v_add_u32 v9, 128, v8
  v_mul_u32_u24 v9, 0xaab, v9
  v_lshrrev_b32 v9, 17, v9
  v_xor_b32 v9, v9, v8
  v_lshlrev_b32 v244, 4, v9
  v_xor_b32 v245, 64, v244
  s_mov_b32 s10, 19267584
  s_mov_b32 s11, 0x00020000
  s_mov_b32 s15, 0x00020000
  s_mov_b32 s18, 0x60000
  s_mov_b32 s19, 0x00020000
  s_mov_b32 s38, 256
  s_mov_b32 s39, 0x00020000
  s_mov_b32 s74, 19267584
  s_mov_b32 s75, 0x00020000
  s_mov_b32 s93, 262144
  s_mov_b32 s94, 263296
  s_mov_b32 s92, 0
  s_waitcnt lgkmcnt(0)
  s_mov_b64 s[8:9], s[4:5]
  s_mov_b64 s[16:17], s[54:55]
  s_mov_b64 s[36:37], s[52:53]
  s_mov_b64 s[12:13], s[42:43]
  s_mov_b64 s[72:73], s[42:43]
  s_sub_u32 s26, s2, 0
  s_cmp_lt_u32 s26, 72
  s_cselect_b64 vcc, -1, 0
  s_cmp_ge_u32 s2, 224
  s_cselect_b64 vcc, -1, vcc
  s_cmp_ge_u32 s2, 72
  s_cbranch_scc1 L_nobh
  s_barrier
L_nobh:
  s_add_u32 m0, s24, 0
  s_mov_b32 s25, s44
  buffer_load_dwordx4 v240, s[8:11], s25 offen offset:0 nt lds
  buffer_load_dwordx4 v242, s[8:11], s25 offen offset:1024 nt lds
  buffer_load_dwordx4 v244, s[8:11], s25 offen offset:2048 nt lds
  s_add_u32 m0, s24, 3072
  s_add_u32 s25, s25, 86016
  buffer_load_dwordx4 v241, s[8:11], s25 offen offset:0 nt lds
  buffer_load_dwordx4 v243, s[8:11], s25 offen offset:1024 nt lds
  buffer_load_dwordx4 v245, s[8:11], s25 offen offset:2048 nt lds
  v_add_u32 v4, 0x10000, v3
  v_add_u32 v5, 0x20000, v3
  v_and_b32 v9, 15, v8
  v_mul_u32_u24 v10, 384, v9
  v_add_u32 v10, s24, v10
  v_bfe_u32 v11, v8, 1, 3
  v_lshrrev_b32 v12, 4, v8
  v_xor_b32 v11, v11, v12
  v_lshl_add_u32 v252, v11, 4, v10
  v_xor_b32 v11, 4, v11
  v_lshl_add_u32 v253, v11, 4, v10
  s_add_u32 s45, s44, 172032
  s_add_u32 s47, s46, 172032
  v_bfe_u32 v9, v8, 3, 1
  v_mul_u32_u24 v9, 86016, v9
  v_and_b32 v10, 7, v8
  v_mul_u32_u24 v10, 384, v10
  v_and_b32 v11, 48, v8
  v_add3_u32 v1, v9, v10, v11
  s_add_u32 m0, s24, 6144
  s_add_u32 s25, s25, 86016
  s_cmp_ge_u32 s2, 36
  s_cbranch_scc1 L_noq
  s_barrier
L_noq:
  s_cbranch_vccnz L_xs6
  s_waitcnt vmcnt(5)
L_xs6:
  buffer_load_dwordx4 v240, s[8:11], s25 offen offset:0 nt lds
  s_cbranch_vccnz L_xs7
  s_waitcnt vmcnt(5)
L_xs7:
  buffer_load_dwordx4 v242, s[8:11], s25 offen offset:1024 nt lds
  s_cbranch_vccnz L_xs8
  s_waitcnt vmcnt(5)
L_xs8:
  s_waitcnt vmcnt(7)
  buffer_load_dwordx4 v244, s[8:11], s25 offen offset:2048 nt lds
  s_add_u32 m0, s24, 9216
  s_add_u32 s25, s25, 86016
  s_cbranch_vccnz L_xs9
  s_waitcnt vmcnt(5)
L_xs9:
  s_waitcnt vmcnt(7)
  buffer_load_dwordx4 v241, s[8:11], s25 offen offset:0 nt lds
  s_cbranch_vccnz L_xs10
  s_waitcnt vmcnt(5)
L_xs10:
  s_waitcnt vmcnt(7)
  buffer_load_dwordx4 v243, s[8:11], s25 offen offset:1024 nt lds
  s_cbranch_vccnz L_xs11
  s_waitcnt vmcnt(5)
L_xs11:
  s_waitcnt vmcnt(7)
  buffer_load_dwordx4 v245, s[8:11], s25 offen offset:2048 nt lds
  s_cmp_lt_u32 s2, 72
  s_cbranch_scc1 L_x4
  s_add_u32 m0, s24, 12288
  s_mov_b32 s25, s46
  s_cbranch_vccnz L_xs12
  s_waitcnt vmcnt(5)
L_xs12:
  s_waitcnt vmcnt(7)
  buffer_load_dwordx4 v240, s[8:11], s25 offen offset:0 nt lds
  s_cbranch_vccnz L_xs13
  s_waitcnt vmcnt(5)
L_xs13:
  s_waitcnt vmcnt(7)
  buffer_load_dwordx4 v242, s[8:11], s25 offen offset:1024 nt lds
  s_cbranch_vccnz L_xs14
  s_waitcnt vmcnt(5)
L_xs14:
  s_waitcnt vmcnt(7)
  buffer_load_dwordx4 v244, s[8:11], s25 offen offset:2048 nt lds
  s_add_u32 m0, s24, 15360
  s_add_u32 s25, s25, 86016
  s_cbranch_vccnz L_xs15
  s_waitcnt vmcnt(5)
L_xs15:
  s_waitcnt vmcnt(7)
  buffer_load_dwordx4 v241, s[8:11], s25 offen offset:0 nt lds
  s_cbranch_vccnz L_xs16
  s_waitcnt vmcnt(5)
L_xs16:
  s_waitcnt vmcnt(7)
  buffer_load_dwordx4 v243, s[8:11], s25 offen offset:1024 nt lds
  s_cbranch_vccnz L_xs17
  s_waitcnt vmcnt(5)
L_xs17:
  s_waitcnt vmcnt(7)
  buffer_load_dwordx4 v245, s[8:11], s25 offen offset:2048 nt lds
  s_waitcnt vmcnt(3)
  s_cbranch_vccnz L_bx
L_x4:
  s_waitcnt vmcnt(0)
L_bx:
  s_barrier
  ds_read_b128 a[0:3], v252 offset:0
  ds_read_b128 a[4:7], v253 offset:0
  ds_read_b128 a[8:11], v252 offset:128
  ds_read_b128 a[12:15], v253 offset:128
  ds_read_b128 a[16:19], v252 offset:256
  ds_read_b128 a[20:23], v253 offset:256
  ds_read_b128 a[24:27], v252 offset:6144
  ds_read_b128 a[28:31], v253 offset:6144
  ds_read_b128 a[32:35], v252 offset:6272
  ds_read_b128 a[36:39], v253 offset:6272
  ds_read_b128 a[40:43], v252 offset:6400
  ds_read_b128 a[44:47], v253 offset:6400
  s_cmp_lt_u32 s2, 72
  s_cselect_b64 vcc, -1, 0
  s_mov_b64 exec, 0
  s_branch L_pad1
L_deep:
  s_add_u32 m0, s24, 12288
  s_mov_b32 s25, s46
  buffer_load_dwordx4 v240, s[8:11], s25 offen offset:0 nt lds
  buffer_load_dwordx4 v242, s[8:11], s25 offen offset:1024 nt lds
  buffer_load_dwordx4 v244, s[8:11], s25 offen offset:2048 nt lds
  s_add_u32 m0, s24, 15360
  s_add_u32 s25, s25, 86016
  buffer_load_dwordx4 v241, s[8:11], s25 offen offset:0 nt lds
  buffer_load_dwordx4 v243, s[8:11], s25 offen offset:1024 nt lds
  buffer_load_dwordx4 v245, s[8:11], s25 offen offset:2048 nt lds
  s_branch L_deepb
.p2align 6
L_pref:
  s_mov_b32 s10, 19267584
  s_mov_b32 s11, 0x00020000
  s_mov_b32 s15, 0x00020000
  s_mov_b32 s18, 0x60000
  s_mov_b32 s19, 0x00020000
  s_mov_b32 s38, 256
  s_mov_b32 s39, 0x00020000
  s_mov_b32 s74, 19267584
  s_mov_b32 s75, 0x00020000
  s_mov_b32 s93, 262144
  s_mov_b32 s94, 263296
  s_mov_b32 s92, 0
  s_mov_b32 s14, 0
  v_mov_b32 v1, 0
  v_min_u32 v2, 35, v8
  v_lshlrev_b32 v2, 5, v2
  s_lshr_b32 s26, s2, 3
  s_mul_i32 s27, s26, 57
  s_lshr_b32 s27, s27, 9
  s_mul_i32 s27, s27, 9
  s_sub_u32 s26, s26, s27
  s_lshl_b32 s26, s26, 13
  v_lshl_add_u32 v28, v8, 7, s26
  s_mov_b32 s3, 90112
  s_waitcnt lgkmcnt(0)
  s_mov_b64 s[8:9], s[4:5]
  s_mov_b64 s[16:17], s[54:55]
  s_mov_b64 s[36:37], s[52:53]
  s_mov_b64 s[12:13], s[42:43]
  s_mov_b64 s[72:73], s[42:43]
  s_getpc_b64 s[48:49]
L_pc:
  s_sub_u32 s48, s48, L_pc-standalone__swin_window_attn__vision_kernel
  s_subb_u32 s49, s49, 0
  s_lshr_b32 s26, s2, 3
  s_and_b32 s26, s26, 3
  s_lshl_b32 s26, s26, 13
  s_add_u32 s26, s26, 1024
  v_lshl_add_u32 v9, v8, 7, s26
  v_min_u32 v9, L_last-standalone__swin_window_attn__vision_kernel, v9
  global_load_dword v29, v9, s[48:49]
  s_add_u32 s21, s2, 1312
  s_and_b32 s22, s21, 1
  s_lshr_b32 s21, s21, 1
  s_mul_hi_u32 s23, s21, 153391690
  s_mul_i32 s24, s23, 28
  s_sub_u32 s24, s21, s24
  s_mul_i32 s23, s23, 688128
  s_mul_i32 s24, s24, 3072
  s_add_u32 s44, s23, s24
  s_mul_i32 s22, s22, 344064
  s_add_u32 s46, s44, 344064
  s_sub_u32 s46, s46, s22
  s_add_u32 s44, s44, s22
  s_mov_b32 s24, 73728
  v_add_u32 v9, 0, v8
  v_mul_u32_u24 v9, 0xaab, v9
  v_lshrrev_b32 v9, 17, v9
  v_xor_b32 v9, v9, v8
  v_lshlrev_b32 v240, 4, v9
  v_xor_b32 v241, 64, v240
  v_add_u32 v9, 64, v8
  v_mul_u32_u24 v9, 0xaab, v9
  v_lshrrev_b32 v9, 17, v9
  v_xor_b32 v9, v9, v8
  v_lshlrev_b32 v242, 4, v9
  v_xor_b32 v243, 64, v242
  v_add_u32 v9, 128, v8
  v_mul_u32_u24 v9, 0xaab, v9
  v_lshrrev_b32 v9, 17, v9
  v_xor_b32 v9, v9, v8
  v_lshlrev_b32 v244, 4, v9
  v_xor_b32 v245, 64, v244
  s_cmp_lt_u32 s2, 224
  s_cbranch_scc1 L_loader
  s_mov_b32 m0, 73728
  s_add_u32 s25, s46, 0
  buffer_load_dwordx4 v240, s[8:11], s25 offen offset:0 nt lds
  buffer_load_dwordx4 v242, s[8:11], s25 offen offset:1024 nt lds
  buffer_load_dwordx4 v244, s[8:11], s25 offen offset:2048 nt lds
  s_mov_b32 m0, 76800
  s_add_u32 s25, s46, 86016
  buffer_load_dwordx4 v241, s[8:11], s25 offen offset:0 nt lds
  buffer_load_dwordx4 v243, s[8:11], s25 offen offset:1024 nt lds
  buffer_load_dwordx4 v245, s[8:11], s25 offen offset:2048 nt lds
  s_mov_b32 m0, 79872
  s_add_u32 s25, s46, 172032
  s_waitcnt vmcnt(5)
  buffer_load_dwordx4 v240, s[8:11], s25 offen offset:0 nt lds
  s_waitcnt vmcnt(5)
  buffer_load_dwordx4 v242, s[8:11], s25 offen offset:1024 nt lds
  s_waitcnt vmcnt(5)
  buffer_load_dwordx4 v244, s[8:11], s25 offen offset:2048 nt lds
  s_mov_b32 m0, 82944
  s_add_u32 s25, s46, 258048
  s_waitcnt vmcnt(5)
  buffer_load_dwordx4 v241, s[8:11], s25 offen offset:0 nt lds
  s_waitcnt vmcnt(5)
  buffer_load_dwordx4 v243, s[8:11], s25 offen offset:1024 nt lds
  s_waitcnt vmcnt(5)
  buffer_load_dwordx4 v245, s[8:11], s25 offen offset:2048 nt lds
  v_add_u32 v4, 0x10000, v3
  v_add_u32 v5, 0x20000, v3
  v_and_b32 v9, 15, v8
  v_mul_u32_u24 v10, 384, v9
  v_add_u32 v10, s24, v10
  v_bfe_u32 v11, v8, 1, 3
  v_lshrrev_b32 v12, 4, v8
  v_xor_b32 v11, v11, v12
  v_lshl_add_u32 v252, v11, 4, v10
  v_xor_b32 v11, 4, v11
  v_lshl_add_u32 v253, v11, 4, v10
  s_add_u32 s45, s44, 172032
  s_add_u32 s47, s46, 172032
  v_bfe_u32 v9, v8, 3, 1
  v_mul_u32_u24 v9, 86016, v9
  v_and_b32 v10, 7, v8
  v_mul_u32_u24 v10, 384, v10
  v_and_b32 v11, 48, v8
  v_add3_u32 v1, v9, v10, v11
  s_branch L_loader
.p2align 12
L_padret:
  s_mov_b64 exec, -1
  s_waitcnt lgkmcnt(0)
  s_barrier
  ds_read_b128 a[96:99], v4 offset:24576
  ds_read_b128 a[100:103], v4 offset:25600
  ds_read_b128 a[104:107], v4 offset:26624
  ds_read_b128 a[108:111], v4 offset:27648
  ds_read_b128 a[112:115], v4 offset:28672
  ds_read_b128 a[116:119], v4 offset:29696
  ds_read_b128 a[120:123], v4 offset:30720
  ds_read_b128 a[124:127], v4 offset:31744
  s_waitcnt lgkmcnt(7)
  v_mfma_f32_16x16x32_bf16 v[20:23], a[96:99], a[0:3], 0
  ds_read_b128 a[128:131], v4 offset:32768
  ds_read_b128 a[132:135], v4 offset:33792
  s_waitcnt lgkmcnt(8)
  v_mfma_f32_16x16x32_bf16 v[20:23], a[100:103], a[4:7], v[20:23]
  ds_read_b128 a[136:139], v4 offset:34816
  ds_read_b128 a[140:143], v4 offset:35840
  s_waitcnt lgkmcnt(9)
  v_mfma_f32_16x16x32_bf16 v[20:23], a[104:107], a[8:11], v[20:23]
  s_waitcnt lgkmcnt(8)
  v_mfma_f32_16x16x32_bf16 v[20:23], a[108:111], a[12:15], v[20:23]
  s_waitcnt lgkmcnt(7)
  v_mfma_f32_16x16x32_bf16 v[20:23], a[112:115], a[16:19], v[20:23]
  s_waitcnt lgkmcnt(6)
  v_mfma_f32_16x16x32_bf16 v[20:23], a[116:119], a[20:23], v[20:23]
  v_mfma_f32_16x16x32_bf16 v[24:27], a[96:99], a[24:27], 0
  v_mfma_f32_16x16x32_bf16 v[24:27], a[100:103], a[28:31], v[24:27]
  v_mfma_f32_16x16x32_bf16 v[24:27], a[104:107], a[32:35], v[24:27]
  v_mfma_f32_16x16x32_bf16 v[24:27], a[108:111], a[36:39], v[24:27]
  v_mfma_f32_16x16x32_bf16 v[24:27], a[112:115], a[40:43], v[24:27]
  s_barrier
  v_mfma_f32_16x16x32_bf16 v[24:27], a[116:119], a[44:47], v[24:27]
  s_waitcnt lgkmcnt(0)
  ds_read_b128 a[96:99], v4 offset:36864
  ds_read_b128 a[100:103], v4 offset:37888
  v_mfma_f32_16x16x32_bf16 v[28:31], a[120:123], a[0:3], 0
  ds_read_b128 a[104:107], v4 offset:38912
  ds_read_b128 a[108:111], v4 offset:39936
  v_mfma_f32_16x16x32_bf16 v[28:31], a[124:127], a[4:7], v[28:31]
  ds_read_b128 a[112:115], v4 offset:40960
  ds_read_b128 a[116:119], v4 offset:41984
  v_mfma_f32_16x16x32_bf16 v[28:31], a[128:131], a[8:11], v[28:31]
  v_cvt_pk_bf16_f32 v48, v20, v21
  v_cvt_pk_bf16_f32 v49, v22, v23
  v_mfma_f32_16x16x32_bf16 v[28:31], a[132:135], a[12:15], v[28:31]
  v_cvt_pk_bf16_f32 v72, v24, v25
  v_cvt_pk_bf16_f32 v73, v26, v27
  v_mfma_f32_16x16x32_bf16 v[28:31], a[136:139], a[16:19], v[28:31]
  v_mfma_f32_16x16x32_bf16 v[28:31], a[140:143], a[20:23], v[28:31]
  v_mfma_f32_16x16x32_bf16 v[32:35], a[120:123], a[24:27], 0
  ds_read_b128 a[120:123], v4 offset:43008
  v_mfma_f32_16x16x32_bf16 v[32:35], a[124:127], a[28:31], v[32:35]
  ds_read_b128 a[124:127], v4 offset:44032
  v_mfma_f32_16x16x32_bf16 v[32:35], a[128:131], a[32:35], v[32:35]
  ds_read_b128 a[128:131], v4 offset:45056
  v_mfma_f32_16x16x32_bf16 v[32:35], a[132:135], a[36:39], v[32:35]
  ds_read_b128 a[132:135], v4 offset:46080
  v_cvt_pk_bf16_f32 v50, v28, v29
  v_mfma_f32_16x16x32_bf16 v[32:35], a[136:139], a[40:43], v[32:35]
  ds_read_b128 a[136:139], v4 offset:47104
  v_cvt_pk_bf16_f32 v51, v30, v31
  v_mfma_f32_16x16x32_bf16 v[32:35], a[140:143], a[44:47], v[32:35]
  s_waitcnt lgkmcnt(5)
  ds_read_b128 a[140:143], v4 offset:48128
  v_mfma_f32_16x16x32_bf16 v[36:39], a[96:99], a[0:3], 0
  v_mfma_f32_16x16x32_bf16 v[36:39], a[100:103], a[4:7], v[36:39]
  v_mfma_f32_16x16x32_bf16 v[36:39], a[104:107], a[8:11], v[36:39]
  v_mfma_f32_16x16x32_bf16 v[36:39], a[108:111], a[12:15], v[36:39]
  v_mfma_f32_16x16x32_bf16 v[36:39], a[112:115], a[16:19], v[36:39]
  v_mfma_f32_16x16x32_bf16 v[36:39], a[116:119], a[20:23], v[36:39]
  v_cvt_pk_bf16_f32 v74, v32, v33
  v_cvt_pk_bf16_f32 v75, v34, v35
  v_mfma_f32_16x16x32_bf16 v[40:43], a[96:99], a[24:27], 0
  v_mfma_f32_16x16x32_bf16 v[40:43], a[100:103], a[28:31], v[40:43]
  v_mfma_f32_16x16x32_bf16 v[40:43], a[104:107], a[32:35], v[40:43]
  v_mfma_f32_16x16x32_bf16 v[40:43], a[108:111], a[36:39], v[40:43]
  v_mfma_f32_16x16x32_bf16 v[40:43], a[112:115], a[40:43], v[40:43]
  s_barrier
  v_mfma_f32_16x16x32_bf16 v[40:43], a[116:119], a[44:47], v[40:43]
  s_waitcnt lgkmcnt(0)
  s_cbranch_vccnz L_deep
L_deepb:
  ds_read_b128 a[96:99], v4 offset:49152
  v_mfma_f32_16x16x32_bf16 v[44:47], a[120:123], a[0:3], 0
  s_add_u32 m0, s24, 18432
  s_add_u32 s25, s25, 86016
  ds_read_b128 a[100:103], v4 offset:50176
  v_mfma_f32_16x16x32_bf16 v[44:47], a[124:127], a[4:7], v[44:47]
  buffer_load_dwordx4 v240, s[8:11], s25 offen offset:0 nt lds
  v_mfma_f32_16x16x32_bf16 v[44:47], a[128:131], a[8:11], v[44:47]
  ds_read_b128 a[104:107], v4 offset:51200
  ds_read_b128 a[108:111], v4 offset:52224
  v_mfma_f32_16x16x32_bf16 v[44:47], a[132:135], a[12:15], v[44:47]
  buffer_load_dwordx4 v242, s[8:11], s25 offen offset:1024 nt lds
  v_mfma_f32_16x16x32_bf16 v[44:47], a[136:139], a[16:19], v[44:47]
  ds_read_b128 a[112:115], v4 offset:53248
  ds_read_b128 a[116:119], v4 offset:54272
  v_mfma_f32_16x16x32_bf16 v[44:47], a[140:143], a[20:23], v[44:47]
  buffer_load_dwordx4 v244, s[8:11], s25 offen offset:2048 nt lds
  v_mfma_f32_16x16x32_bf16 v[16:19], a[120:123], a[24:27], 0
  s_add_u32 m0, s24, 21504
  s_add_u32 s25, s25, 86016
  ds_read_b128 a[120:123], v4 offset:55296
  v_mfma_f32_16x16x32_bf16 v[16:19], a[124:127], a[28:31], v[16:19]
  buffer_load_dwordx4 v241, s[8:11], s25 offen offset:0 nt lds
  v_mfma_f32_16x16x32_bf16 v[16:19], a[128:131], a[32:35], v[16:19]
  ds_read_b128 a[124:127], v4 offset:56320
  ds_read_b128 a[128:131], v4 offset:57344
  v_mfma_f32_16x16x32_bf16 v[16:19], a[132:135], a[36:39], v[16:19]
  buffer_load_dwordx4 v243, s[8:11], s25 offen offset:1024 nt lds
  v_mfma_f32_16x16x32_bf16 v[16:19], a[136:139], a[40:43], v[16:19]
  ds_read_b128 a[132:135], v4 offset:58368
  ds_read_b128 a[136:139], v4 offset:59392
  v_mfma_f32_16x16x32_bf16 v[16:19], a[140:143], a[44:47], v[16:19]
  s_waitcnt lgkmcnt(9)
  buffer_load_dwordx4 v245, s[8:11], s25 offen offset:2048 nt lds
  v_mfma_f32_16x16x32_bf16 v[20:23], a[96:99], a[0:3], 0
  ds_read_b128 a[140:143], v4 offset:60416
  v_cvt_pk_bf16_f32 v52, v36, v37
  v_mfma_f32_16x16x32_bf16 v[20:23], a[100:103], a[4:7], v[20:23]
  s_waitcnt lgkmcnt(8)
  v_cvt_pk_bf16_f32 v53, v38, v39
  v_cvt_pk_bf16_f32 v76, v40, v41
  v_mfma_f32_16x16x32_bf16 v[20:23], a[104:107], a[8:11], v[20:23]
  v_cvt_pk_bf16_f32 v77, v42, v43
  v_cvt_pk_bf16_f32 v54, v44, v45
  v_mfma_f32_16x16x32_bf16 v[20:23], a[108:111], a[12:15], v[20:23]
  s_waitcnt lgkmcnt(6)
  v_cvt_pk_bf16_f32 v55, v46, v47
  v_cvt_pk_bf16_f32 v78, v16, v17
  v_mfma_f32_16x16x32_bf16 v[20:23], a[112:115], a[16:19], v[20:23]
  v_cvt_pk_bf16_f32 v79, v18, v19
  v_mfma_f32_16x16x32_bf16 v[20:23], a[116:119], a[20:23], v[20:23]
  v_mfma_f32_16x16x32_bf16 v[24:27], a[96:99], a[24:27], 0
  v_mfma_f32_16x16x32_bf16 v[24:27], a[100:103], a[28:31], v[24:27]
  v_mfma_f32_16x16x32_bf16 v[24:27], a[104:107], a[32:35], v[24:27]
  v_mfma_f32_16x16x32_bf16 v[24:27], a[108:111], a[36:39], v[24:27]
  v_mfma_f32_16x16x32_bf16 v[24:27], a[112:115], a[40:43], v[24:27]
  s_barrier
  v_mfma_f32_16x16x32_bf16 v[24:27], a[116:119], a[44:47], v[24:27]
  s_waitcnt lgkmcnt(0)
  ds_read_b128 a[96:99], v4 offset:61440
  ds_read_b128 a[100:103], v4 offset:62464
  v_mfma_f32_16x16x32_bf16 v[28:31], a[120:123], a[0:3], 0
  ds_read_b128 a[104:107], v4 offset:63488
  ds_read_b128 a[108:111], v4 offset:64512
  v_mfma_f32_16x16x32_bf16 v[28:31], a[124:127], a[4:7], v[28:31]
  ds_read_b128 a[112:115], v5 offset:0
  ds_read_b128 a[116:119], v5 offset:1024
  v_mfma_f32_16x16x32_bf16 v[28:31], a[128:131], a[8:11], v[28:31]
  v_cvt_pk_bf16_f32 v56, v20, v21
  v_cvt_pk_bf16_f32 v57, v22, v23
  v_mfma_f32_16x16x32_bf16 v[28:31], a[132:135], a[12:15], v[28:31]
  v_cvt_pk_bf16_f32 v80, v24, v25
  v_cvt_pk_bf16_f32 v81, v26, v27
  v_mfma_f32_16x16x32_bf16 v[28:31], a[136:139], a[16:19], v[28:31]
  v_mfma_f32_16x16x32_bf16 v[28:31], a[140:143], a[20:23], v[28:31]
  v_mfma_f32_16x16x32_bf16 v[32:35], a[120:123], a[24:27], 0
  ds_read_b128 a[120:123], v5 offset:2048
  v_mfma_f32_16x16x32_bf16 v[32:35], a[124:127], a[28:31], v[32:35]
  ds_read_b128 a[124:127], v5 offset:3072
  v_mfma_f32_16x16x32_bf16 v[32:35], a[128:131], a[32:35], v[32:35]
  ds_read_b128 a[128:131], v5 offset:4096
  v_mfma_f32_16x16x32_bf16 v[32:35], a[132:135], a[36:39], v[32:35]
  ds_read_b128 a[132:135], v5 offset:5120
  v_cvt_pk_bf16_f32 v58, v28, v29
  v_mfma_f32_16x16x32_bf16 v[32:35], a[136:139], a[40:43], v[32:35]
  ds_read_b128 a[136:139], v5 offset:6144
  v_cvt_pk_bf16_f32 v59, v30, v31
  v_mfma_f32_16x16x32_bf16 v[32:35], a[140:143], a[44:47], v[32:35]
  s_waitcnt lgkmcnt(5)
  ds_read_b128 a[140:143], v5 offset:7168
  v_mfma_f32_16x16x32_bf16 v[36:39], a[96:99], a[0:3], 0
  v_mfma_f32_16x16x32_bf16 v[36:39], a[100:103], a[4:7], v[36:39]
  v_mfma_f32_16x16x32_bf16 v[36:39], a[104:107], a[8:11], v[36:39]
  v_mfma_f32_16x16x32_bf16 v[36:39], a[108:111], a[12:15], v[36:39]
  v_mfma_f32_16x16x32_bf16 v[36:39], a[112:115], a[16:19], v[36:39]
  v_mfma_f32_16x16x32_bf16 v[36:39], a[116:119], a[20:23], v[36:39]
  v_cvt_pk_bf16_f32 v82, v32, v33
  v_cvt_pk_bf16_f32 v83, v34, v35
  v_mfma_f32_16x16x32_bf16 v[40:43], a[96:99], a[24:27], 0
  v_mfma_f32_16x16x32_bf16 v[40:43], a[100:103], a[28:31], v[40:43]
  v_mfma_f32_16x16x32_bf16 v[40:43], a[104:107], a[32:35], v[40:43]
  v_mfma_f32_16x16x32_bf16 v[40:43], a[108:111], a[36:39], v[40:43]
  v_mfma_f32_16x16x32_bf16 v[40:43], a[112:115], a[40:43], v[40:43]
  s_barrier
  v_mfma_f32_16x16x32_bf16 v[40:43], a[116:119], a[44:47], v[40:43]
  s_waitcnt lgkmcnt(0)
  ds_read_b128 a[96:99], v5 offset:8192
  ds_read_b128 a[100:103], v5 offset:9216
  v_mfma_f32_16x16x32_bf16 v[44:47], a[120:123], a[0:3], 0
  ds_read_b128 a[104:107], v5 offset:10240
  ds_read_b128 a[108:111], v5 offset:11264
  v_mfma_f32_16x16x32_bf16 v[44:47], a[124:127], a[4:7], v[44:47]
  ds_read_b128 a[112:115], v5 offset:12288
  ds_read_b128 a[116:119], v5 offset:13312
  v_mfma_f32_16x16x32_bf16 v[44:47], a[128:131], a[8:11], v[44:47]
  v_cvt_pk_bf16_f32 v60, v36, v37
  v_cvt_pk_bf16_f32 v61, v38, v39
  v_mfma_f32_16x16x32_bf16 v[44:47], a[132:135], a[12:15], v[44:47]
  v_cvt_pk_bf16_f32 v84, v40, v41
  v_cvt_pk_bf16_f32 v85, v42, v43
  v_mfma_f32_16x16x32_bf16 v[44:47], a[136:139], a[16:19], v[44:47]
  v_mfma_f32_16x16x32_bf16 v[44:47], a[140:143], a[20:23], v[44:47]
  v_mfma_f32_16x16x32_bf16 v[16:19], a[120:123], a[24:27], 0
  ds_read_b128 a[120:123], v5 offset:14336
  v_mfma_f32_16x16x32_bf16 v[16:19], a[124:127], a[28:31], v[16:19]
  ds_read_b128 a[124:127], v5 offset:15360
  v_mfma_f32_16x16x32_bf16 v[16:19], a[128:131], a[32:35], v[16:19]
  ds_read_b128 a[128:131], v5 offset:16384
  v_mfma_f32_16x16x32_bf16 v[16:19], a[132:135], a[36:39], v[16:19]
  ds_read_b128 a[132:135], v5 offset:17408
  v_cvt_pk_bf16_f32 v62, v44, v45
  v_mfma_f32_16x16x32_bf16 v[16:19], a[136:139], a[40:43], v[16:19]
  ds_read_b128 a[136:139], v5 offset:18432
  v_cvt_pk_bf16_f32 v63, v46, v47
  v_mfma_f32_16x16x32_bf16 v[16:19], a[140:143], a[44:47], v[16:19]
  s_waitcnt lgkmcnt(5)
  ds_read_b128 a[140:143], v5 offset:19456
  v_mfma_f32_16x16x32_bf16 v[20:23], a[96:99], a[0:3], 0
  v_mfma_f32_16x16x32_bf16 v[20:23], a[100:103], a[4:7], v[20:23]
  v_mfma_f32_16x16x32_bf16 v[20:23], a[104:107], a[8:11], v[20:23]
  v_mfma_f32_16x16x32_bf16 v[20:23], a[108:111], a[12:15], v[20:23]
  v_mfma_f32_16x16x32_bf16 v[20:23], a[112:115], a[16:19], v[20:23]
  v_mfma_f32_16x16x32_bf16 v[20:23], a[116:119], a[20:23], v[20:23]
  v_cvt_pk_bf16_f32 v86, v16, v17
  v_cvt_pk_bf16_f32 v87, v18, v19
  v_mfma_f32_16x16x32_bf16 v[24:27], a[96:99], a[24:27], 0
  ds_read_b128 a[96:99], v5 offset:20480
  v_mfma_f32_16x16x32_bf16 v[24:27], a[100:103], a[28:31], v[24:27]
  ds_read_b128 a[100:103], v5 offset:21504
  v_mfma_f32_16x16x32_bf16 v[24:27], a[104:107], a[32:35], v[24:27]
  s_add_u32 m0, s24, 0
  ds_read_b128 a[104:107], v5 offset:22528
  v_cvt_pk_bf16_f32 v64, v20, v21
  v_mfma_f32_16x16x32_bf16 v[24:27], a[108:111], a[36:39], v[24:27]
  buffer_load_dwordx4 v3, s[16:19], m0 offen offset:0 sc1 lds
  v_mfma_f32_16x16x32_bf16 v[24:27], a[112:115], a[40:43], v[24:27]
  ds_read_b128 a[108:111], v5 offset:23552
  ds_read_b128 a[112:115], v5 offset:24576
  v_mfma_f32_16x16x32_bf16 v[24:27], a[116:119], a[44:47], v[24:27]
  s_waitcnt lgkmcnt(5)
  ds_read_b128 a[116:119], v5 offset:25600
  v_cvt_pk_bf16_f32 v65, v22, v23
  v_mfma_f32_16x16x32_bf16 v[28:31], a[120:123], a[0:3], 0
  buffer_load_dwordx4 v3, s[16:19], m0 offen offset:1024 sc1 lds
  v_mfma_f32_16x16x32_bf16 v[28:31], a[124:127], a[4:7], v[28:31]
  v_mfma_f32_16x16x32_bf16 v[28:31], a[128:131], a[8:11], v[28:31]
  v_mfma_f32_16x16x32_bf16 v[28:31], a[132:135], a[12:15], v[28:31]
  v_cvt_pk_bf16_f32 v88, v24, v25
  v_cvt_pk_bf16_f32 v89, v26, v27
  v_mfma_f32_16x16x32_bf16 v[28:31], a[136:139], a[16:19], v[28:31]
  buffer_load_dwordx4 v3, s[16:19], m0 offen offset:2048 sc1 lds
  v_mfma_f32_16x16x32_bf16 v[28:31], a[140:143], a[20:23], v[28:31]
  v_mfma_f32_16x16x32_bf16 v[32:35], a[120:123], a[24:27], 0
  ds_read_b128 a[120:123], v5 offset:26624
  v_mfma_f32_16x16x32_bf16 v[32:35], a[124:127], a[28:31], v[32:35]
  ds_read_b128 a[124:127], v5 offset:27648
  v_mfma_f32_16x16x32_bf16 v[32:35], a[128:131], a[32:35], v[32:35]
  s_add_u32 m0, s24, 3072
  ds_read_b128 a[128:131], v5 offset:28672
  v_mfma_f32_16x16x32_bf16 v[32:35], a[132:135], a[36:39], v[32:35]
  buffer_load_dwordx4 v3, s[16:19], m0 offen offset:0 sc1 lds
  v_mfma_f32_16x16x32_bf16 v[32:35], a[136:139], a[40:43], v[32:35]
  ds_read_b128 a[132:135], v5 offset:29696
  ds_read_b128 a[136:139], v5 offset:30720
  v_mfma_f32_16x16x32_bf16 v[32:35], a[140:143], a[44:47], v[32:35]
  s_waitcnt lgkmcnt(5)
  ds_read_b128 a[140:143], v5 offset:31744
  v_cvt_pk_bf16_f32 v66, v28, v29
  v_mfma_f32_16x16x32_bf16 v[36:39], a[96:99], a[0:3], 0
  buffer_load_dwordx4 v3, s[16:19], m0 offen offset:1024 sc1 lds
  v_mfma_f32_16x16x32_bf16 v[36:39], a[100:103], a[4:7], v[36:39]
  v_cvt_pk_bf16_f32 v67, v30, v31
  v_mfma_f32_16x16x32_bf16 v[36:39], a[104:107], a[8:11], v[36:39]
  v_cvt_pk_bf16_f32 v90, v32, v33
  v_cvt_pk_bf16_f32 v91, v34, v35
  v_mfma_f32_16x16x32_bf16 v[36:39], a[108:111], a[12:15], v[36:39]
  v_mfma_f32_16x16x32_bf16 v[36:39], a[112:115], a[16:19], v[36:39]
  buffer_load_dwordx4 v3, s[16:19], m0 offen offset:2048 sc1 lds
  v_mfma_f32_16x16x32_bf16 v[36:39], a[116:119], a[20:23], v[36:39]
  s_waitcnt lgkmcnt(4)
  v_mfma_f32_16x16x32_bf16 v[40:43], a[120:123], a[0:3], 0
  v_mfma_f32_16x16x32_bf16 v[40:43], a[124:127], a[4:7], v[40:43]
  s_waitcnt lgkmcnt(3)
  v_mfma_f32_16x16x32_bf16 v[40:43], a[128:131], a[8:11], v[40:43]
  s_waitcnt lgkmcnt(1)
  s_add_u32 m0, s24, 6144
  s_nop 0
  v_mfma_f32_16x16x32_bf16 v[40:43], a[132:135], a[12:15], v[40:43]
  buffer_load_dwordx4 v3, s[16:19], m0 offen offset:0 sc1 lds
  v_mfma_f32_16x16x32_bf16 v[40:43], a[136:139], a[16:19], v[40:43]
  s_waitcnt lgkmcnt(0)
  v_cvt_pk_bf16_f32 v68, v36, v37
  v_cvt_pk_bf16_f32 v69, v38, v39
  v_mfma_f32_16x16x32_bf16 v[40:43], a[140:143], a[20:23], v[40:43]
  v_mfma_f32_16x16x32_bf16 v[44:47], a[96:99], a[24:27], 0
  buffer_load_dwordx4 v3, s[16:19], m0 offen offset:1024 sc1 lds
  v_mfma_f32_16x16x32_bf16 v[44:47], a[100:103], a[28:31], v[44:47]
  ds_read_b128 a[96:99], v4 offset:24576
  ds_read_b128 a[100:103], v4 offset:25600
  v_mfma_f32_16x16x32_bf16 v[44:47], a[104:107], a[32:35], v[44:47]
  ds_read_b128 a[104:107], v4 offset:26624
  v_mfma_f32_16x16x32_bf16 v[44:47], a[108:111], a[36:39], v[44:47]
  v_cvt_pk_bf16_f32 v70, v40, v41
  v_cvt_pk_bf16_f32 v71, v42, v43
  v_mfma_f32_16x16x32_bf16 v[44:47], a[112:115], a[40:43], v[44:47]
  buffer_load_dwordx4 v3, s[16:19], m0 offen offset:2048 sc1 lds
  v_mfma_f32_16x16x32_bf16 v[44:47], a[116:119], a[44:47], v[44:47]
  ds_read_b128 a[108:111], v4 offset:27648
  ds_read_b128 a[112:115], v4 offset:28672
  v_mfma_f32_16x16x32_bf16 v[16:19], a[120:123], a[24:27], 0
  ds_read_b128 a[116:119], v4 offset:29696
  ds_read_b128 a[120:123], v4 offset:30720
  v_mfma_f32_16x16x32_bf16 v[16:19], a[124:127], a[28:31], v[16:19]
  ds_read_b128 a[124:127], v4 offset:31744
  v_mfma_f32_16x16x32_bf16 v[16:19], a[128:131], a[32:35], v[16:19]
  s_add_u32 m0, s24, 9216
  v_cvt_pk_bf16_f32 v92, v44, v45
  v_cvt_pk_bf16_f32 v93, v46, v47
  v_mfma_f32_16x16x32_bf16 v[16:19], a[132:135], a[36:39], v[16:19]
  buffer_load_dwordx4 v3, s[16:19], m0 offen offset:0 sc1 lds
  v_mfma_f32_16x16x32_bf16 v[16:19], a[136:139], a[40:43], v[16:19]
  ds_read_b128 a[128:131], v4 offset:32768
  ds_read_b128 a[132:135], v4 offset:33792
  v_mfma_f32_16x16x32_bf16 v[16:19], a[140:143], a[44:47], v[16:19]
  ds_read_b128 a[136:139], v4 offset:34816
  ds_read_b128 a[140:143], v4 offset:35840
  v_mfma_f32_16x16x32_bf16 v[96:99], a[0:3], v[48:51], 0
  buffer_load_dwordx4 v3, s[16:19], m0 offen offset:1024 sc1 lds
  v_mfma_f32_16x16x32_bf16 v[96:99], a[4:7], v[52:55], v[96:99]
  v_mfma_f32_16x16x32_bf16 v[96:99], a[8:11], v[56:59], v[96:99]
  v_mfma_f32_16x16x32_bf16 v[96:99], a[12:15], v[60:63], v[96:99]
  v_mfma_f32_16x16x32_bf16 v[96:99], a[16:19], v[64:67], v[96:99]
  buffer_load_dwordx4 v3, s[16:19], m0 offen offset:2048 sc1 lds
  v_mfma_f32_16x16x32_bf16 v[96:99], a[20:23], v[68:71], v[96:99]
  v_cvt_pk_bf16_f32 v94, v16, v17
  v_cvt_pk_bf16_f32 v95, v18, v19
  v_mfma_f32_16x16x32_bf16 v[100:103], a[24:27], v[48:51], 0
  v_mfma_f32_16x16x32_bf16 v[100:103], a[28:31], v[52:55], v[100:103]
  v_mfma_f32_16x16x32_bf16 v[100:103], a[32:35], v[56:59], v[100:103]
  v_mfma_f32_16x16x32_bf16 v[100:103], a[36:39], v[60:63], v[100:103]
  v_mfma_f32_16x16x32_bf16 v[100:103], a[40:43], v[64:67], v[100:103]
  s_waitcnt vmcnt(18)
  v_max3_f32 v7, v96, v97, v98
  v_mfma_f32_16x16x32_bf16 v[100:103], a[44:47], v[68:71], v[100:103]
  ds_read_b128 a[48:51], v252 offset:12288
  ds_read_b128 a[52:55], v253 offset:12288
  v_mfma_f32_16x16x32_bf16 v[112:115], a[0:3], v[72:75], 0
  s_waitcnt lgkmcnt(2)
  ds_read_b128 a[56:59], v252 offset:12416
  ds_read_b128 a[60:63], v253 offset:12416
  v_mfma_f32_16x16x32_bf16 v[112:115], a[4:7], v[76:79], v[112:115]
  ds_read_b128 a[64:67], v252 offset:12544
  ds_read_b128 a[68:71], v253 offset:12544
  v_mfma_f32_16x16x32_bf16 v[112:115], a[8:11], v[80:83], v[112:115]
  v_max3_f32 v7, v7, v99, v100
  v_max3_f32 v7, v7, v101, v102
  v_mfma_f32_16x16x32_bf16 v[112:115], a[12:15], v[84:87], v[112:115]
  v_mfma_f32_16x16x32_bf16 v[112:115], a[16:19], v[88:91], v[112:115]
  v_mfma_f32_16x16x32_bf16 v[112:115], a[20:23], v[92:95], v[112:115]
  v_mfma_f32_16x16x32_bf16 v[116:119], a[24:27], v[72:75], 0
  v_mfma_f32_16x16x32_bf16 v[116:119], a[28:31], v[76:79], v[116:119]
  v_mfma_f32_16x16x32_bf16 v[116:119], a[32:35], v[80:83], v[116:119]
  s_waitcnt vmcnt(12)
  v_mfma_f32_16x16x32_bf16 v[116:119], a[36:39], v[84:87], v[116:119]
  s_waitcnt lgkmcnt(0)
  s_add_u32 m0, s24, 12288
  ds_read_b128 a[72:75], v252 offset:18432
  ds_read_b128 a[76:79], v253 offset:18432
  v_mfma_f32_16x16x32_bf16 v[116:119], a[40:43], v[88:91], v[116:119]
  buffer_load_dwordx4 v3, s[16:19], m0 offen offset:0 sc1 lds
  v_mfma_f32_16x16x32_bf16 v[116:119], a[44:47], v[92:95], v[116:119]
  ds_read_b128 a[80:83], v252 offset:18560
  ds_read_b128 a[84:87], v253 offset:18560
  v_mfma_f32_16x16x32_bf16 v[104:107], a[48:51], v[48:51], 0
  buffer_load_dwordx4 v3, s[16:19], m0 offen offset:1024 sc1 lds
  v_mfma_f32_16x16x32_bf16 v[104:107], a[52:55], v[52:55], v[104:107]
  ds_read_b128 a[88:91], v252 offset:18688
  ds_read_b128 a[92:95], v253 offset:18688
  v_mfma_f32_16x16x32_bf16 v[104:107], a[56:59], v[56:59], v[104:107]
  buffer_load_dwordx4 v3, s[16:19], m0 offen offset:2048 sc1 lds
  v_mfma_f32_16x16x32_bf16 v[104:107], a[60:63], v[60:63], v[104:107]
  s_add_u32 m0, s24, 15360
  v_max3_f32 v11, v112, v113, v114
  v_max3_f32 v11, v11, v115, v116
  v_mfma_f32_16x16x32_bf16 v[104:107], a[64:67], v[64:67], v[104:107]
  buffer_load_dwordx4 v3, s[16:19], m0 offen offset:0 sc1 lds
  v_mfma_f32_16x16x32_bf16 v[104:107], a[68:71], v[68:71], v[104:107]
  v_max3_f32 v11, v11, v117, v118
  v_mfma_f32_16x16x32_bf16 v[120:123], a[48:51], v[72:75], 0
  buffer_load_dwordx4 v3, s[16:19], m0 offen offset:1024 sc1 lds
  v_mfma_f32_16x16x32_bf16 v[120:123], a[52:55], v[76:79], v[120:123]
  v_mfma_f32_16x16x32_bf16 v[120:123], a[56:59], v[80:83], v[120:123]
  buffer_load_dwordx4 v3, s[16:19], m0 offen offset:2048 sc1 lds
  v_mfma_f32_16x16x32_bf16 v[120:123], a[60:63], v[84:87], v[120:123]
  s_waitcnt lgkmcnt(0)
  s_add_u32 m0, s24, 18432
  v_max3_f32 v7, v7, v103, v104
  v_mfma_f32_16x16x32_bf16 v[120:123], a[64:67], v[88:91], v[120:123]
  buffer_load_dwordx4 v3, s[16:19], m0 offen offset:0 sc1 lds
  v_mfma_f32_16x16x32_bf16 v[120:123], a[68:71], v[92:95], v[120:123]
  v_max3_f32 v7, v7, v105, v106
  v_mfma_f32_16x16x32_bf16 v[108:111], a[72:75], v[48:51], 0
  buffer_load_dwordx4 v3, s[16:19], m0 offen offset:1024 sc1 lds
  v_mfma_f32_16x16x32_bf16 v[108:111], a[76:79], v[52:55], v[108:111]
  v_mfma_f32_16x16x32_bf16 v[108:111], a[80:83], v[56:59], v[108:111]
  buffer_load_dwordx4 v3, s[16:19], m0 offen offset:2048 sc1 lds
  v_mfma_f32_16x16x32_bf16 v[108:111], a[84:87], v[60:63], v[108:111]
  s_add_u32 m0, s24, 21504
  v_max3_f32 v11, v11, v119, v120
  v_max3_f32 v11, v11, v121, v122
  v_mfma_f32_16x16x32_bf16 v[108:111], a[88:91], v[64:67], v[108:111]
  buffer_load_dwordx4 v3, s[16:19], m0 offen offset:0 sc1 lds
  v_mfma_f32_16x16x32_bf16 v[108:111], a[92:95], v[68:71], v[108:111]
  v_mfma_f32_16x16x32_bf16 v[124:127], a[72:75], v[72:75], 0
  buffer_load_dwordx4 v3, s[16:19], m0 offen offset:1024 sc1 lds
  v_mfma_f32_16x16x32_bf16 v[124:127], a[76:79], v[76:79], v[124:127]
  v_mfma_f32_16x16x32_bf16 v[124:127], a[80:83], v[80:83], v[124:127]
  buffer_load_dwordx4 v3, s[16:19], m0 offen offset:2048 sc1 lds
  v_mfma_f32_16x16x32_bf16 v[124:127], a[84:87], v[84:87], v[124:127]
  v_mfma_f32_16x16x32_bf16 v[124:127], a[88:91], v[88:91], v[124:127]
  v_mfma_f32_16x16x32_bf16 v[124:127], a[92:95], v[92:95], v[124:127]
  v_max3_f32 v7, v7, v107, v108
  v_max3_f32 v7, v7, v109, v110
L_join:
  v_mfma_f32_16x16x32_bf16 v[20:23], a[96:99], a[48:51], 0
  v_max_f32 v7, v7, v111
  v_mov_b32 v8, v7
  v_mfma_f32_16x16x32_bf16 v[20:23], a[100:103], a[52:55], v[20:23]
  v_mfma_f32_16x16x32_bf16 v[20:23], a[104:107], a[56:59], v[20:23]
  v_permlane32_swap_b32 v7, v8
  v_mfma_f32_16x16x32_bf16 v[20:23], a[108:111], a[60:63], v[20:23]
  v_max_f32 v7, v7, v8
  v_mov_b32 v8, v7
  v_mfma_f32_16x16x32_bf16 v[20:23], a[112:115], a[64:67], v[20:23]
  v_max3_f32 v11, v11, v123, v124
  v_max3_f32 v11, v11, v125, v126
  v_mfma_f32_16x16x32_bf16 v[20:23], a[116:119], a[68:71], v[20:23]
  v_permlane16_swap_b32 v7, v8
  v_mfma_f32_16x16x32_bf16 v[24:27], a[96:99], a[72:75], 0
  ds_read_b128 a[96:99], v4 offset:36864
  v_max_f32 v7, v7, v8
  v_mfma_f32_16x16x32_bf16 v[24:27], a[100:103], a[76:79], v[24:27]
  ds_read_b128 a[100:103], v4 offset:37888
  v_sub_f32 v96, v96, v7
  v_mfma_f32_16x16x32_bf16 v[24:27], a[104:107], a[80:83], v[24:27]
  ds_read_b128 a[104:107], v4 offset:38912
  v_cvt_pk_bf16_f32 v48, v20, v21
  v_mfma_f32_16x16x32_bf16 v[24:27], a[108:111], a[84:87], v[24:27]
  ds_read_b128 a[108:111], v4 offset:39936
  v_cvt_pk_bf16_f32 v49, v22, v23
  v_mfma_f32_16x16x32_bf16 v[24:27], a[112:115], a[88:91], v[24:27]
  ds_read_b128 a[112:115], v4 offset:40960
  v_sub_f32 v97, v97, v7
  v_mfma_f32_16x16x32_bf16 v[24:27], a[116:119], a[92:95], v[24:27]
  ds_read_b128 a[116:119], v4 offset:41984
  v_sub_f32 v98, v98, v7
  v_mfma_f32_16x16x32_bf16 v[28:31], a[120:123], a[48:51], 0
  v_exp_f32 v96, v96
  v_mfma_f32_16x16x32_bf16 v[28:31], a[124:127], a[52:55], v[28:31]
  v_exp_f32 v97, v97
  v_mfma_f32_16x16x32_bf16 v[28:31], a[128:131], a[56:59], v[28:31]
  v_exp_f32 v98, v98
  v_mfma_f32_16x16x32_bf16 v[28:31], a[132:135], a[60:63], v[28:31]
  v_cvt_pk_bf16_f32 v72, v24, v25
  v_cvt_pk_bf16_f32 v73, v26, v27
  v_mfma_f32_16x16x32_bf16 v[28:31], a[136:139], a[64:67], v[28:31]
  v_sub_f32 v99, v99, v7
  v_sub_f32 v100, v100, v7
  v_mfma_f32_16x16x32_bf16 v[28:31], a[140:143], a[68:71], v[28:31]
  v_exp_f32 v99, v99
  v_mfma_f32_16x16x32_bf16 v[32:35], a[120:123], a[72:75], 0
  ds_read_b128 a[120:123], v4 offset:43008
  v_add_f32 v9, v96, v97
  v_mfma_f32_16x16x32_bf16 v[32:35], a[124:127], a[76:79], v[32:35]
  ds_read_b128 a[124:127], v4 offset:44032
  v_sub_f32 v101, v101, v7
  v_mfma_f32_16x16x32_bf16 v[32:35], a[128:131], a[80:83], v[32:35]
  ds_read_b128 a[128:131], v4 offset:45056
  v_cvt_pk_bf16_f32 v50, v28, v29
  v_mfma_f32_16x16x32_bf16 v[32:35], a[132:135], a[84:87], v[32:35]
  ds_read_b128 a[132:135], v4 offset:46080
  v_cvt_pk_bf16_f32 v51, v30, v31
  v_mfma_f32_16x16x32_bf16 v[32:35], a[136:139], a[88:91], v[32:35]
  ds_read_b128 a[136:139], v4 offset:47104
  v_add_f32 v9, v9, v98
  v_mfma_f32_16x16x32_bf16 v[32:35], a[140:143], a[92:95], v[32:35]
  s_waitcnt lgkmcnt(5)
  ds_read_b128 a[140:143], v4 offset:48128
  v_sub_f32 v102, v102, v7
  v_mfma_f32_16x16x32_bf16 v[36:39], a[96:99], a[48:51], 0
  v_exp_f32 v100, v100
  v_mfma_f32_16x16x32_bf16 v[36:39], a[100:103], a[52:55], v[36:39]
  v_exp_f32 v101, v101
  v_mfma_f32_16x16x32_bf16 v[36:39], a[104:107], a[56:59], v[36:39]
  v_cvt_pk_bf16_f32 v74, v32, v33
  v_cvt_pk_bf16_f32 v75, v34, v35
  v_mfma_f32_16x16x32_bf16 v[36:39], a[108:111], a[60:63], v[36:39]
  v_add_f32 v9, v9, v99
  v_sub_f32 v103, v103, v7
  v_mfma_f32_16x16x32_bf16 v[36:39], a[112:115], a[64:67], v[36:39]
  v_exp_f32 v102, v102
  v_mfma_f32_16x16x32_bf16 v[36:39], a[116:119], a[68:71], v[36:39]
  v_add_f32 v9, v9, v100
  v_sub_f32 v104, v104, v7
  v_mfma_f32_16x16x32_bf16 v[40:43], a[96:99], a[72:75], 0
  ds_read_b128 a[96:99], v4 offset:49152
  v_add_f32 v9, v9, v101
  v_mfma_f32_16x16x32_bf16 v[40:43], a[100:103], a[76:79], v[40:43]
  ds_read_b128 a[100:103], v4 offset:50176
  v_sub_f32 v105, v105, v7
  v_mfma_f32_16x16x32_bf16 v[40:43], a[104:107], a[80:83], v[40:43]
  ds_read_b128 a[104:107], v4 offset:51200
  v_cvt_pk_bf16_f32 v52, v36, v37
  v_mfma_f32_16x16x32_bf16 v[40:43], a[108:111], a[84:87], v[40:43]
  ds_read_b128 a[108:111], v4 offset:52224
  v_cvt_pk_bf16_f32 v53, v38, v39
  v_mfma_f32_16x16x32_bf16 v[40:43], a[112:115], a[88:91], v[40:43]
  ds_read_b128 a[112:115], v4 offset:53248
  v_add_f32 v9, v9, v102
  v_mfma_f32_16x16x32_bf16 v[40:43], a[116:119], a[92:95], v[40:43]
  s_waitcnt lgkmcnt(5)
  ds_read_b128 a[116:119], v4 offset:54272
  v_sub_f32 v106, v106, v7
  v_mfma_f32_16x16x32_bf16 v[44:47], a[120:123], a[48:51], 0
  v_exp_f32 v103, v103
  v_mfma_f32_16x16x32_bf16 v[44:47], a[124:127], a[52:55], v[44:47]
  v_exp_f32 v104, v104
  v_mfma_f32_16x16x32_bf16 v[44:47], a[128:131], a[56:59], v[44:47]
  v_cvt_pk_bf16_f32 v76, v40, v41
  v_cvt_pk_bf16_f32 v77, v42, v43
  v_mfma_f32_16x16x32_bf16 v[44:47], a[132:135], a[60:63], v[44:47]
  v_exp_f32 v105, v105
  v_mfma_f32_16x16x32_bf16 v[44:47], a[136:139], a[64:67], v[44:47]
  v_add_f32 v9, v9, v103
  v_sub_f32 v107, v107, v7
  v_mfma_f32_16x16x32_bf16 v[44:47], a[140:143], a[68:71], v[44:47]
  v_exp_f32 v106, v106
  v_mfma_f32_16x16x32_bf16 v[16:19], a[120:123], a[72:75], 0
  ds_read_b128 a[120:123], v4 offset:55296
  v_add_f32 v9, v9, v104
  v_mfma_f32_16x16x32_bf16 v[16:19], a[124:127], a[76:79], v[16:19]
  ds_read_b128 a[124:127], v4 offset:56320
  v_sub_f32 v108, v108, v7
  v_mfma_f32_16x16x32_bf16 v[16:19], a[128:131], a[80:83], v[16:19]
  ds_read_b128 a[128:131], v4 offset:57344
  v_cvt_pk_bf16_f32 v54, v44, v45
  v_mfma_f32_16x16x32_bf16 v[16:19], a[132:135], a[84:87], v[16:19]
  ds_read_b128 a[132:135], v4 offset:58368
  v_cvt_pk_bf16_f32 v55, v46, v47
L_pad1:
  s_cbranch_execz L_pad2
  v_mfma_f32_16x16x32_bf16 v[16:19], a[136:139], a[88:91], v[16:19]
  ds_read_b128 a[136:139], v4 offset:59392
  v_add_f32 v9, v9, v105
  v_mfma_f32_16x16x32_bf16 v[16:19], a[140:143], a[92:95], v[16:19]
  s_waitcnt lgkmcnt(5)
  ds_read_b128 a[140:143], v4 offset:60416
  v_sub_f32 v109, v109, v7
  v_mfma_f32_16x16x32_bf16 v[20:23], a[96:99], a[48:51], 0
  v_exp_f32 v107, v107
  v_mfma_f32_16x16x32_bf16 v[20:23], a[100:103], a[52:55], v[20:23]
  v_exp_f32 v108, v108
  v_mfma_f32_16x16x32_bf16 v[20:23], a[104:107], a[56:59], v[20:23]
  v_cvt_pk_bf16_f32 v78, v16, v17
  v_cvt_pk_bf16_f32 v79, v18, v19
  v_mfma_f32_16x16x32_bf16 v[20:23], a[108:111], a[60:63], v[20:23]
  v_add_f32 v9, v9, v106
  v_sub_f32 v110, v110, v7
  v_mfma_f32_16x16x32_bf16 v[20:23], a[112:115], a[64:67], v[20:23]
  v_exp_f32 v109, v109
  v_mfma_f32_16x16x32_bf16 v[20:23], a[116:119], a[68:71], v[20:23]
  v_add_f32 v9, v9, v107
  v_sub_f32 v111, v111, v7
  v_mfma_f32_16x16x32_bf16 v[24:27], a[96:99], a[72:75], 0
  ds_read_b128 a[96:99], v4 offset:61440
  v_add_f32 v9, v9, v108
  v_mfma_f32_16x16x32_bf16 v[24:27], a[100:103], a[76:79], v[24:27]
  ds_read_b128 a[100:103], v4 offset:62464
  v_add_f32 v9, v9, v109
  v_mfma_f32_16x16x32_bf16 v[24:27], a[104:107], a[80:83], v[24:27]
  ds_read_b128 a[104:107], v4 offset:63488
  v_cvt_pk_bf16_f32 v56, v20, v21
  v_mfma_f32_16x16x32_bf16 v[24:27], a[108:111], a[84:87], v[24:27]
  ds_read_b128 a[108:111], v4 offset:64512
  v_cvt_pk_bf16_f32 v57, v22, v23
  v_mfma_f32_16x16x32_bf16 v[24:27], a[112:115], a[88:91], v[24:27]
  ds_read_b128 a[112:115], v5 offset:0
  v_max_f32 v11, v11, v127
  v_mfma_f32_16x16x32_bf16 v[24:27], a[116:119], a[92:95], v[24:27]
  s_waitcnt lgkmcnt(5)
  ds_read_b128 a[116:119], v5 offset:1024
  v_mov_b32 v12, v11
  v_mfma_f32_16x16x32_bf16 v[28:31], a[120:123], a[48:51], 0
  v_exp_f32 v110, v110
  v_mfma_f32_16x16x32_bf16 v[28:31], a[124:127], a[52:55], v[28:31]
  v_exp_f32 v111, v111
  v_mfma_f32_16x16x32_bf16 v[28:31], a[128:131], a[56:59], v[28:31]
  v_cvt_pk_bf16_f32 v80, v24, v25
  v_cvt_pk_bf16_f32 v81, v26, v27
  v_mfma_f32_16x16x32_bf16 v[28:31], a[132:135], a[60:63], v[28:31]
  v_add_f32 v9, v9, v110
  v_add_f32 v9, v9, v111
  v_mfma_f32_16x16x32_bf16 v[28:31], a[136:139], a[64:67], v[28:31]
  v_mov_b32 v10, v9
  v_mfma_f32_16x16x32_bf16 v[28:31], a[140:143], a[68:71], v[28:31]
  v_permlane32_swap_b32 v11, v12
  v_mfma_f32_16x16x32_bf16 v[32:35], a[120:123], a[72:75], 0
  ds_read_b128 a[120:123], v5 offset:2048
  v_max_f32 v11, v11, v12
  v_mfma_f32_16x16x32_bf16 v[32:35], a[124:127], a[76:79], v[32:35]
  ds_read_b128 a[124:127], v5 offset:3072
  v_mov_b32 v12, v11
  v_mfma_f32_16x16x32_bf16 v[32:35], a[128:131], a[80:83], v[32:35]
  ds_read_b128 a[128:131], v5 offset:4096
  v_cvt_pk_bf16_f32 v58, v28, v29
  v_mfma_f32_16x16x32_bf16 v[32:35], a[132:135], a[84:87], v[32:35]
  ds_read_b128 a[132:135], v5 offset:5120
  v_cvt_pk_bf16_f32 v59, v30, v31
  v_mfma_f32_16x16x32_bf16 v[32:35], a[136:139], a[88:91], v[32:35]
  ds_read_b128 a[136:139], v5 offset:6144
  v_mfma_f32_16x16x32_bf16 v[32:35], a[140:143], a[92:95], v[32:35]
  s_waitcnt lgkmcnt(5)
  ds_read_b128 a[140:143], v5 offset:7168
  v_mfma_f32_16x16x32_bf16 v[36:39], a[96:99], a[48:51], 0
  v_permlane32_swap_b32 v9, v10
  v_mfma_f32_16x16x32_bf16 v[36:39], a[100:103], a[52:55], v[36:39]
  v_add_f32 v9, v9, v10
  v_mov_b32 v10, v9
  v_mfma_f32_16x16x32_bf16 v[36:39], a[104:107], a[56:59], v[36:39]
  v_cvt_pk_bf16_f32 v82, v32, v33
  v_cvt_pk_bf16_f32 v83, v34, v35
  v_mfma_f32_16x16x32_bf16 v[36:39], a[108:111], a[60:63], v[36:39]
  v_permlane16_swap_b32 v9, v10
  v_mfma_f32_16x16x32_bf16 v[36:39], a[112:115], a[64:67], v[36:39]
  v_add_f32 v9, v9, v10
  v_mfma_f32_16x16x32_bf16 v[36:39], a[116:119], a[68:71], v[36:39]
  v_rcp_f32 v9, v9
  v_mfma_f32_16x16x32_bf16 v[40:43], a[96:99], a[72:75], 0
  ds_read_b128 a[96:99], v5 offset:8192
  v_mul_f32 v96, v96, v9
  v_mfma_f32_16x16x32_bf16 v[40:43], a[100:103], a[76:79], v[40:43]
  ds_read_b128 a[100:103], v5 offset:9216
  v_mul_f32 v97, v97, v9
  v_mfma_f32_16x16x32_bf16 v[40:43], a[104:107], a[80:83], v[40:43]
  ds_read_b128 a[104:107], v5 offset:10240
  v_cvt_pk_bf16_f32 v60, v36, v37
  v_mfma_f32_16x16x32_bf16 v[40:43], a[108:111], a[84:87], v[40:43]
  ds_read_b128 a[108:111], v5 offset:11264
  v_cvt_pk_bf16_f32 v61, v38, v39
  v_mfma_f32_16x16x32_bf16 v[40:43], a[112:115], a[88:91], v[40:43]
  ds_read_b128 a[112:115], v5 offset:12288
  v_mul_f32 v98, v98, v9
  v_mfma_f32_16x16x32_bf16 v[40:43], a[116:119], a[92:95], v[40:43]
  s_waitcnt lgkmcnt(5)
  ds_read_b128 a[116:119], v5 offset:13312
  v_mul_f32 v99, v99, v9
  v_mfma_f32_16x16x32_bf16 v[44:47], a[120:123], a[48:51], 0
  v_permlane16_swap_b32 v11, v12
  v_mfma_f32_16x16x32_bf16 v[44:47], a[124:127], a[52:55], v[44:47]
  v_max_f32 v11, v11, v12
  v_mul_f32 v100, v100, v9
  v_mfma_f32_16x16x32_bf16 v[44:47], a[128:131], a[56:59], v[44:47]
  v_cvt_pk_bf16_f32 v84, v40, v41
  v_cvt_pk_bf16_f32 v85, v42, v43
  v_mfma_f32_16x16x32_bf16 v[44:47], a[132:135], a[60:63], v[44:47]
  v_mul_f32 v101, v101, v9
  v_mul_f32 v102, v102, v9
  v_mfma_f32_16x16x32_bf16 v[44:47], a[136:139], a[64:67], v[44:47]
  v_mul_f32 v103, v103, v9
  v_sub_f32 v112, v112, v11
  v_mfma_f32_16x16x32_bf16 v[44:47], a[140:143], a[68:71], v[44:47]
  v_sub_f32 v113, v113, v11
  v_cvt_pk_bf16_f32 v160, v96, v97
  v_mfma_f32_16x16x32_bf16 v[16:19], a[120:123], a[72:75], 0
  ds_read_b128 a[120:123], v5 offset:14336
  v_cvt_pk_bf16_f32 v161, v98, v99
  v_mfma_f32_16x16x32_bf16 v[16:19], a[124:127], a[76:79], v[16:19]
  ds_read_b128 a[124:127], v5 offset:15360
  v_cvt_pk_bf16_f32 v162, v100, v101
  v_mfma_f32_16x16x32_bf16 v[16:19], a[128:131], a[80:83], v[16:19]
  ds_read_b128 a[128:131], v5 offset:16384
  v_cvt_pk_bf16_f32 v62, v44, v45
  v_mfma_f32_16x16x32_bf16 v[16:19], a[132:135], a[84:87], v[16:19]
  ds_read_b128 a[132:135], v5 offset:17408
  v_cvt_pk_bf16_f32 v63, v46, v47
  v_mfma_f32_16x16x32_bf16 v[16:19], a[136:139], a[88:91], v[16:19]
  ds_read_b128 a[136:139], v5 offset:18432
  v_cvt_pk_bf16_f32 v163, v102, v103
  v_mfma_f32_16x16x32_bf16 v[16:19], a[140:143], a[92:95], v[16:19]
  s_waitcnt lgkmcnt(5)
  ds_read_b128 a[140:143], v5 offset:19456
  v_sub_f32 v114, v114, v11
  v_mfma_f32_16x16x32_bf16 v[20:23], a[96:99], a[48:51], 0
  s_waitcnt vmcnt(0)
  s_barrier
  v_mfma_f32_16x16x32_bf16 v[20:23], a[100:103], a[52:55], v[20:23]
  v_exp_f32 v112, v112
  v_mfma_f32_16x16x32_bf16 v[20:23], a[104:107], a[56:59], v[20:23]
  v_cvt_pk_bf16_f32 v86, v16, v17
  v_cvt_pk_bf16_f32 v87, v18, v19
  v_mfma_f32_16x16x32_bf16 v[20:23], a[108:111], a[60:63], v[20:23]
  v_exp_f32 v113, v113
  v_mfma_f32_16x16x32_bf16 v[20:23], a[112:115], a[64:67], v[20:23]
  v_mul_f32 v104, v104, v9
  v_mul_f32 v105, v105, v9
  v_mfma_f32_16x16x32_bf16 v[20:23], a[116:119], a[68:71], v[20:23]
  v_mul_f32 v106, v106, v9
  v_mul_f32 v107, v107, v9
  v_mfma_f32_16x16x32_bf16 v[24:27], a[96:99], a[72:75], 0
  ds_read_b128 a[96:99], v5 offset:20480
  v_mul_f32 v108, v108, v9
  v_mfma_f32_16x16x32_bf16 v[24:27], a[100:103], a[76:79], v[24:27]
  ds_read_b128 a[100:103], v5 offset:21504
  v_mul_f32 v109, v109, v9
  v_mfma_f32_16x16x32_bf16 v[24:27], a[104:107], a[80:83], v[24:27]
  ds_read_b128 a[104:107], v5 offset:22528
  v_cvt_pk_bf16_f32 v64, v20, v21
  v_mfma_f32_16x16x32_bf16 v[24:27], a[108:111], a[84:87], v[24:27]
  ds_read_b128 a[108:111], v5 offset:23552
  v_cvt_pk_bf16_f32 v65, v22, v23
  v_mfma_f32_16x16x32_bf16 v[24:27], a[112:115], a[88:91], v[24:27]
  ds_read_b128 a[112:115], v5 offset:24576
  v_mul_f32 v110, v110, v9
  v_mfma_f32_16x16x32_bf16 v[24:27], a[116:119], a[92:95], v[24:27]
  s_waitcnt lgkmcnt(5)
  ds_read_b128 a[116:119], v5 offset:25600
  v_mul_f32 v111, v111, v9
  v_mfma_f32_16x16x32_bf16 v[28:31], a[120:123], a[48:51], 0
  v_exp_f32 v114, v114
  v_mfma_f32_16x16x32_bf16 v[28:31], a[124:127], a[52:55], v[28:31]
  v_sub_f32 v115, v115, v11
  v_cvt_pk_bf16_f32 v164, v104, v105
  v_mfma_f32_16x16x32_bf16 v[28:31], a[128:131], a[56:59], v[28:31]
  v_cvt_pk_bf16_f32 v88, v24, v25
  v_cvt_pk_bf16_f32 v89, v26, v27
  v_mfma_f32_16x16x32_bf16 v[28:31], a[132:135], a[60:63], v[28:31]
  v_cvt_pk_bf16_f32 v165, v106, v107
  v_cvt_pk_bf16_f32 v166, v108, v109
  v_mfma_f32_16x16x32_bf16 v[28:31], a[136:139], a[64:67], v[28:31]
  v_cvt_pk_bf16_f32 v167, v110, v111
  v_sub_f32 v116, v116, v11
  v_mfma_f32_16x16x32_bf16 v[28:31], a[140:143], a[68:71], v[28:31]
  v_exp_f32 v115, v115
  v_mfma_f32_16x16x32_bf16 v[32:35], a[120:123], a[72:75], 0
  ds_read_b128 a[120:123], v5 offset:26624
  v_add_f32 v13, v112, v113
  v_mfma_f32_16x16x32_bf16 v[32:35], a[124:127], a[76:79], v[32:35]
  ds_read_b128 a[124:127], v5 offset:27648
  v_sub_f32 v117, v117, v11
  v_mfma_f32_16x16x32_bf16 v[32:35], a[128:131], a[80:83], v[32:35]
  ds_read_b128 a[128:131], v5 offset:28672
  v_cvt_pk_bf16_f32 v66, v28, v29
  v_mfma_f32_16x16x32_bf16 v[32:35], a[132:135], a[84:87], v[32:35]
  ds_read_b128 a[132:135], v5 offset:29696
  v_cvt_pk_bf16_f32 v67, v30, v31
  v_mfma_f32_16x16x32_bf16 v[32:35], a[136:139], a[88:91], v[32:35]
  ds_read_b128 a[136:139], v5 offset:30720
  v_add_f32 v13, v13, v114
  v_mfma_f32_16x16x32_bf16 v[32:35], a[140:143], a[92:95], v[32:35]
  s_waitcnt lgkmcnt(5)
  ds_read_b128 a[140:143], v5 offset:31744
  v_sub_f32 v118, v118, v11
  v_mfma_f32_16x16x32_bf16 v[36:39], a[96:99], a[48:51], 0
  v_exp_f32 v116, v116
  v_mfma_f32_16x16x32_bf16 v[36:39], a[100:103], a[52:55], v[36:39]
  v_exp_f32 v117, v117
  v_mfma_f32_16x16x32_bf16 v[36:39], a[104:107], a[56:59], v[36:39]
  v_cvt_pk_bf16_f32 v90, v32, v33
  v_cvt_pk_bf16_f32 v91, v34, v35
  v_mfma_f32_16x16x32_bf16 v[36:39], a[108:111], a[60:63], v[36:39]
  v_add_f32 v13, v13, v115
  v_sub_f32 v119, v119, v11
  v_mfma_f32_16x16x32_bf16 v[36:39], a[112:115], a[64:67], v[36:39]
  v_exp_f32 v118, v118
  v_mfma_f32_16x16x32_bf16 v[36:39], a[116:119], a[68:71], v[36:39]
  s_waitcnt lgkmcnt(4)
  v_add_f32 v13, v13, v116
  v_sub_f32 v120, v120, v11
  v_mfma_f32_16x16x32_bf16 v[40:43], a[120:123], a[48:51], 0
  v_exp_f32 v119, v119
  v_mfma_f32_16x16x32_bf16 v[40:43], a[124:127], a[52:55], v[40:43]
  s_waitcnt lgkmcnt(2)
  v_add_f32 v13, v13, v117
  v_cvt_pk_bf16_f32 v68, v36, v37
  v_mfma_f32_16x16x32_bf16 v[40:43], a[128:131], a[56:59], v[40:43]
  v_cvt_pk_bf16_f32 v69, v38, v39
  v_sub_f32 v121, v121, v11
  v_mfma_f32_16x16x32_bf16 v[40:43], a[132:135], a[60:63], v[40:43]
  s_waitcnt lgkmcnt(0)
  v_exp_f32 v120, v120
  v_mfma_f32_16x16x32_bf16 v[40:43], a[136:139], a[64:67], v[40:43]
  v_add_f32 v13, v13, v118
  v_sub_f32 v122, v122, v11
  v_mfma_f32_16x16x32_bf16 v[40:43], a[140:143], a[68:71], v[40:43]
  v_exp_f32 v121, v121
  v_mfma_f32_16x16x32_bf16 v[44:47], a[96:99], a[72:75], 0
  ds_read_b128 a[96:99], v3 offset:0
  v_add_f32 v13, v13, v119
  v_mfma_f32_16x16x32_bf16 v[44:47], a[100:103], a[76:79], v[44:47]
  ds_read_b128 a[100:103], v3 offset:1024
  v_sub_f32 v123, v123, v11
  v_mfma_f32_16x16x32_bf16 v[44:47], a[104:107], a[80:83], v[44:47]
  v_cvt_pk_bf16_f32 v70, v40, v41
  v_cvt_pk_bf16_f32 v71, v42, v43
  v_mfma_f32_16x16x32_bf16 v[44:47], a[108:111], a[84:87], v[44:47]
  ds_read_b128 a[104:107], v3 offset:2048
  ds_read_b128 a[108:111], v3 offset:3072
  v_mfma_f32_16x16x32_bf16 v[44:47], a[112:115], a[88:91], v[44:47]
  ds_read_b128 a[112:115], v3 offset:4096
  v_add_f32 v13, v13, v120
  v_mfma_f32_16x16x32_bf16 v[44:47], a[116:119], a[92:95], v[44:47]
  ds_read_b128 a[116:119], v3 offset:5120
  v_sub_f32 v124, v124, v11
  v_mfma_f32_16x16x32_bf16 v[16:19], a[120:123], a[72:75], 0
  ds_read_b128 a[120:123], v3 offset:6144
  v_add_f32 v13, v13, v121
  v_mfma_f32_16x16x32_bf16 v[16:19], a[124:127], a[76:79], v[16:19]
  ds_read_b128 a[124:127], v3 offset:7168
  v_sub_f32 v125, v125, v11
  v_mfma_f32_16x16x32_bf16 v[16:19], a[128:131], a[80:83], v[16:19]
  v_cvt_pk_bf16_f32 v92, v44, v45
  v_cvt_pk_bf16_f32 v93, v46, v47
  v_mfma_f32_16x16x32_bf16 v[16:19], a[132:135], a[84:87], v[16:19]
  ds_read_b128 a[128:131], v3 offset:8192
  ds_read_b128 a[132:135], v3 offset:9216
  v_mfma_f32_16x16x32_bf16 v[16:19], a[136:139], a[88:91], v[16:19]
  ds_read_b128 a[136:139], v3 offset:10240
  v_sub_f32 v126, v126, v11
  v_mfma_f32_16x16x32_bf16 v[16:19], a[140:143], a[92:95], v[16:19]
  ds_read_b128 a[140:143], v3 offset:11264
  v_sub_f32 v127, v127, v11
  v_mfma_f32_16x16x32_bf16 v[128:131], a[0:3], v[48:51], 0
  v_exp_f32 v122, v122
  v_mfma_f32_16x16x32_bf16 v[128:131], a[4:7], v[52:55], v[128:131]
  v_exp_f32 v123, v123
  v_mfma_f32_16x16x32_bf16 v[128:131], a[8:11], v[56:59], v[128:131]
  v_exp_f32 v124, v124
  v_mfma_f32_16x16x32_bf16 v[128:131], a[12:15], v[60:63], v[128:131]
  v_cvt_pk_bf16_f32 v94, v16, v17
  v_cvt_pk_bf16_f32 v95, v18, v19
  v_mfma_f32_16x16x32_bf16 v[128:131], a[16:19], v[64:67], v[128:131]
  v_add_f32 v13, v13, v122
  v_add_f32 v13, v13, v123
  v_mfma_f32_16x16x32_bf16 v[128:131], a[20:23], v[68:71], v[128:131]
  v_exp_f32 v125, v125
  v_mfma_f32_16x16x32_bf16 v[132:135], a[24:27], v[48:51], 0
  v_exp_f32 v126, v126
  v_mfma_f32_16x16x32_bf16 v[132:135], a[28:31], v[52:55], v[132:135]
  v_add_f32 v13, v13, v124
  v_add_f32 v13, v13, v125
  v_mfma_f32_16x16x32_bf16 v[132:135], a[32:35], v[56:59], v[132:135]
  v_exp_f32 v127, v127
  v_mfma_f32_16x16x32_bf16 v[132:135], a[36:39], v[60:63], v[132:135]
  v_add_f32 v13, v13, v126
  v_add_f32 v13, v13, v127
  v_mfma_f32_16x16x32_bf16 v[132:135], a[40:43], v[64:67], v[132:135]
  v_mov_b32 v14, v13
  v_max3_f32 v7, v128, v129, v130
  v_mfma_f32_16x16x32_bf16 v[132:135], a[44:47], v[68:71], v[132:135]
  v_permlane32_swap_b32 v13, v14
  v_mfma_f32_16x16x32_bf16 v[136:139], a[48:51], v[48:51], 0
  v_add_f32 v13, v13, v14
  v_mov_b32 v14, v13
  v_mfma_f32_16x16x32_bf16 v[136:139], a[52:55], v[52:55], v[136:139]
  v_mfma_f32_16x16x32_bf16 v[136:139], a[56:59], v[56:59], v[136:139]
  v_permlane16_swap_b32 v13, v14
  v_mfma_f32_16x16x32_bf16 v[136:139], a[60:63], v[60:63], v[136:139]
  v_add_f32 v13, v13, v14
  v_max3_f32 v7, v7, v131, v132
  v_mfma_f32_16x16x32_bf16 v[136:139], a[64:67], v[64:67], v[136:139]
  v_rcp_f32 v13, v13
  v_mfma_f32_16x16x32_bf16 v[136:139], a[68:71], v[68:71], v[136:139]
  v_mul_f32 v112, v112, v13
  v_mul_f32 v113, v113, v13
  v_mfma_f32_16x16x32_bf16 v[140:143], a[72:75], v[48:51], 0
  v_mul_f32 v114, v114, v13
  v_mul_f32 v115, v115, v13
  v_mfma_f32_16x16x32_bf16 v[140:143], a[76:79], v[52:55], v[140:143]
  v_mul_f32 v116, v116, v13
  v_mul_f32 v117, v117, v13
  v_mfma_f32_16x16x32_bf16 v[140:143], a[80:83], v[56:59], v[140:143]
  v_mul_f32 v118, v118, v13
  v_mul_f32 v119, v119, v13
  v_mfma_f32_16x16x32_bf16 v[140:143], a[84:87], v[60:63], v[140:143]
  v_cvt_pk_bf16_f32 v168, v112, v113
  v_cvt_pk_bf16_f32 v169, v114, v115
  v_mfma_f32_16x16x32_bf16 v[140:143], a[88:91], v[64:67], v[140:143]
  v_cvt_pk_bf16_f32 v170, v116, v117
  v_cvt_pk_bf16_f32 v171, v118, v119
  v_mfma_f32_16x16x32_bf16 v[140:143], a[92:95], v[68:71], v[140:143]
  v_mul_f32 v120, v120, v13
  v_mul_f32 v121, v121, v13
  v_mfma_f32_16x16x32_bf16 v[144:147], a[0:3], v[72:75], 0
  v_mul_f32 v122, v122, v13
  v_mul_f32 v123, v123, v13
  v_mfma_f32_16x16x32_bf16 v[144:147], a[4:7], v[76:79], v[144:147]
  v_mul_f32 v124, v124, v13
  v_mul_f32 v125, v125, v13
  v_mfma_f32_16x16x32_bf16 v[144:147], a[8:11], v[80:83], v[144:147]
  v_mul_f32 v126, v126, v13
  v_mul_f32 v127, v127, v13
  v_mfma_f32_16x16x32_bf16 v[144:147], a[12:15], v[84:87], v[144:147]
  v_cvt_pk_bf16_f32 v172, v120, v121
  v_cvt_pk_bf16_f32 v173, v122, v123
  v_mfma_f32_16x16x32_bf16 v[144:147], a[16:19], v[88:91], v[144:147]
  v_cvt_pk_bf16_f32 v174, v124, v125
  v_cvt_pk_bf16_f32 v175, v126, v127
  v_mfma_f32_16x16x32_bf16 v[144:147], a[20:23], v[92:95], v[144:147]
  v_max3_f32 v7, v7, v133, v134
  v_max3_f32 v7, v7, v135, v136
  v_mfma_f32_16x16x32_bf16 v[148:151], a[24:27], v[72:75], 0
  v_max3_f32 v7, v7, v137, v138
  v_max3_f32 v7, v7, v139, v140
  v_mfma_f32_16x16x32_bf16 v[148:151], a[28:31], v[76:79], v[148:151]
  v_max3_f32 v7, v7, v141, v142
  v_max_f32 v7, v7, v143
  v_mfma_f32_16x16x32_bf16 v[148:151], a[32:35], v[80:83], v[148:151]
  v_mov_b32 v8, v7
  v_max3_f32 v11, v144, v145, v146
  v_mfma_f32_16x16x32_bf16 v[148:151], a[36:39], v[84:87], v[148:151]
  v_permlane32_swap_b32 v7, v8
  v_mfma_f32_16x16x32_bf16 v[148:151], a[40:43], v[88:91], v[148:151]
  v_max_f32 v7, v7, v8
  v_mov_b32 v8, v7
  v_mfma_f32_16x16x32_bf16 v[148:151], a[44:47], v[92:95], v[148:151]
  v_mfma_f32_16x16x32_bf16 v[152:155], a[48:51], v[72:75], 0
  v_permlane16_swap_b32 v7, v8
  v_mfma_f32_16x16x32_bf16 v[152:155], a[52:55], v[76:79], v[152:155]
  v_max_f32 v7, v7, v8
  v_sub_f32 v128, v128, v7
  v_mfma_f32_16x16x32_bf16 v[152:155], a[56:59], v[80:83], v[152:155]
  v_sub_f32 v129, v129, v7
  v_sub_f32 v130, v130, v7
  v_mfma_f32_16x16x32_bf16 v[152:155], a[60:63], v[84:87], v[152:155]
  v_exp_f32 v128, v128
  v_mfma_f32_16x16x32_bf16 v[152:155], a[64:67], v[88:91], v[152:155]
  v_exp_f32 v129, v129
  v_mfma_f32_16x16x32_bf16 v[152:155], a[68:71], v[92:95], v[152:155]
  v_exp_f32 v130, v130
  v_mfma_f32_16x16x32_bf16 v[156:159], a[72:75], v[72:75], 0
  v_sub_f32 v131, v131, v7
  v_sub_f32 v132, v132, v7
  v_mfma_f32_16x16x32_bf16 v[156:159], a[76:79], v[76:79], v[156:159]
  v_exp_f32 v131, v131
  v_mfma_f32_16x16x32_bf16 v[156:159], a[80:83], v[80:83], v[156:159]
  v_add_f32 v9, v128, v129
  v_sub_f32 v133, v133, v7
  v_mfma_f32_16x16x32_bf16 v[156:159], a[84:87], v[84:87], v[156:159]
  v_exp_f32 v132, v132
  v_mfma_f32_16x16x32_bf16 v[156:159], a[88:91], v[88:91], v[156:159]
  v_add_f32 v9, v9, v130
  v_sub_f32 v134, v134, v7
  v_mfma_f32_16x16x32_bf16 v[156:159], a[92:95], v[92:95], v[156:159]
  s_waitcnt lgkmcnt(0)
  v_exp_f32 v133, v133
  v_mfma_f32_16x16x32_bf16 v[20:23], a[0:3], a[96:99], 0
  v_add_f32 v9, v9, v131
  v_sub_f32 v135, v135, v7
  v_mfma_f32_16x16x32_bf16 v[20:23], a[4:7], a[100:103], v[20:23]
  v_exp_f32 v134, v134
  v_mfma_f32_16x16x32_bf16 v[20:23], a[8:11], a[104:107], v[20:23]
  v_add_f32 v9, v9, v132
  v_sub_f32 v136, v136, v7
  v_mfma_f32_16x16x32_bf16 v[20:23], a[12:15], a[108:111], v[20:23]
  v_exp_f32 v135, v135
  v_mfma_f32_16x16x32_bf16 v[20:23], a[16:19], a[112:115], v[20:23]
  v_add_f32 v9, v9, v133
  v_sub_f32 v137, v137, v7
  v_mfma_f32_16x16x32_bf16 v[20:23], a[20:23], a[116:119], v[20:23]
  v_exp_f32 v136, v136
  v_mfma_f32_16x16x32_bf16 v[24:27], a[24:27], a[96:99], 0
  v_add_f32 v9, v9, v134
  v_sub_f32 v138, v138, v7
  v_mfma_f32_16x16x32_bf16 v[24:27], a[28:31], a[100:103], v[24:27]
  v_exp_f32 v137, v137
  v_mfma_f32_16x16x32_bf16 v[24:27], a[32:35], a[104:107], v[24:27]
  v_add_f32 v9, v9, v135
  v_cvt_pk_bf16_f32 v192, v20, v21
  v_mfma_f32_16x16x32_bf16 v[24:27], a[36:39], a[108:111], v[24:27]
  v_cvt_pk_bf16_f32 v193, v22, v23
  v_sub_f32 v139, v139, v7
  v_mfma_f32_16x16x32_bf16 v[24:27], a[40:43], a[112:115], v[24:27]
  v_exp_f32 v138, v138
  v_mfma_f32_16x16x32_bf16 v[24:27], a[44:47], a[116:119], v[24:27]
  v_add_f32 v9, v9, v136
  v_sub_f32 v140, v140, v7
  v_mfma_f32_16x16x32_bf16 v[28:31], a[48:51], a[96:99], 0
  v_exp_f32 v139, v139
  v_mfma_f32_16x16x32_bf16 v[28:31], a[52:55], a[100:103], v[28:31]
  v_add_f32 v9, v9, v137
  v_sub_f32 v141, v141, v7
  v_mfma_f32_16x16x32_bf16 v[28:31], a[56:59], a[104:107], v[28:31]
  v_cvt_pk_bf16_f32 v194, v24, v25
  v_cvt_pk_bf16_f32 v195, v26, v27
  v_mfma_f32_16x16x32_bf16 v[28:31], a[60:63], a[108:111], v[28:31]
  v_exp_f32 v140, v140
  v_mfma_f32_16x16x32_bf16 v[28:31], a[64:67], a[112:115], v[28:31]
  v_add_f32 v9, v9, v138
  v_sub_f32 v142, v142, v7
  v_mfma_f32_16x16x32_bf16 v[28:31], a[68:71], a[116:119], v[28:31]
  v_exp_f32 v141, v141
  v_mfma_f32_16x16x32_bf16 v[32:35], a[72:75], a[96:99], 0
  ds_read_b128 a[96:99], v3 offset:12288
  v_add_f32 v9, v9, v139
  v_mfma_f32_16x16x32_bf16 v[32:35], a[76:79], a[100:103], v[32:35]
  ds_read_b128 a[100:103], v3 offset:13312
  v_sub_f32 v143, v143, v7
  v_mfma_f32_16x16x32_bf16 v[32:35], a[80:83], a[104:107], v[32:35]
  ds_read_b128 a[104:107], v3 offset:14336
  v_cvt_pk_bf16_f32 v196, v28, v29
  v_mfma_f32_16x16x32_bf16 v[32:35], a[84:87], a[108:111], v[32:35]
  ds_read_b128 a[108:111], v3 offset:15360
  v_cvt_pk_bf16_f32 v197, v30, v31
  v_mfma_f32_16x16x32_bf16 v[32:35], a[88:91], a[112:115], v[32:35]
  ds_read_b128 a[112:115], v3 offset:16384
  v_add_f32 v9, v9, v140
  v_mfma_f32_16x16x32_bf16 v[32:35], a[92:95], a[116:119], v[32:35]
  ds_read_b128 a[116:119], v3 offset:17408
  v_add_f32 v9, v9, v141
  v_mfma_f32_16x16x32_bf16 v[36:39], a[0:3], a[120:123], 0
  v_exp_f32 v142, v142
  v_mfma_f32_16x16x32_bf16 v[36:39], a[4:7], a[124:127], v[36:39]
  v_exp_f32 v143, v143
  v_mfma_f32_16x16x32_bf16 v[36:39], a[8:11], a[128:131], v[36:39]
  v_add_f32 v9, v9, v142
  v_cvt_pk_bf16_f32 v198, v32, v33
  v_mfma_f32_16x16x32_bf16 v[36:39], a[12:15], a[132:135], v[36:39]
  v_cvt_pk_bf16_f32 v199, v34, v35
  v_add_f32 v9, v9, v143
  v_mfma_f32_16x16x32_bf16 v[36:39], a[16:19], a[136:139], v[36:39]
  v_mov_b32 v10, v9
  v_max3_f32 v11, v11, v147, v148
  v_mfma_f32_16x16x32_bf16 v[36:39], a[20:23], a[140:143], v[36:39]
  v_permlane32_swap_b32 v9, v10
  v_mfma_f32_16x16x32_bf16 v[40:43], a[24:27], a[120:123], 0
  v_add_f32 v9, v9, v10
  v_max3_f32 v11, v11, v149, v150
  v_mfma_f32_16x16x32_bf16 v[40:43], a[28:31], a[124:127], v[40:43]
  v_mov_b32 v10, v9
  v_max3_f32 v11, v11, v151, v152
  v_mfma_f32_16x16x32_bf16 v[40:43], a[32:35], a[128:131], v[40:43]
  v_cvt_pk_bf16_f32 v200, v36, v37
  v_cvt_pk_bf16_f32 v201, v38, v39
  v_mfma_f32_16x16x32_bf16 v[40:43], a[36:39], a[132:135], v[40:43]
  v_max3_f32 v11, v11, v153, v154
  v_max3_f32 v11, v11, v155, v156
  v_mfma_f32_16x16x32_bf16 v[40:43], a[40:43], a[136:139], v[40:43]
  v_max3_f32 v11, v11, v157, v158
  v_max_f32 v11, v11, v159
  v_mfma_f32_16x16x32_bf16 v[40:43], a[44:47], a[140:143], v[40:43]
  v_permlane16_swap_b32 v9, v10
  v_mfma_f32_16x16x32_bf16 v[44:47], a[48:51], a[120:123], 0
  v_add_f32 v9, v9, v10
  v_mov_b32 v12, v11
  v_mfma_f32_16x16x32_bf16 v[44:47], a[52:55], a[124:127], v[44:47]
  v_rcp_f32 v9, v9
  v_mfma_f32_16x16x32_bf16 v[44:47], a[56:59], a[128:131], v[44:47]
  v_mul_f32 v128, v128, v9
  v_cvt_pk_bf16_f32 v202, v40, v41
  v_mfma_f32_16x16x32_bf16 v[44:47], a[60:63], a[132:135], v[44:47]
  v_cvt_pk_bf16_f32 v203, v42, v43
  v_mul_f32 v129, v129, v9
  v_mfma_f32_16x16x32_bf16 v[44:47], a[64:67], a[136:139], v[44:47]
  v_mul_f32 v130, v130, v9
  v_mul_f32 v131, v131, v9
  v_mfma_f32_16x16x32_bf16 v[44:47], a[68:71], a[140:143], v[44:47]
  v_mul_f32 v132, v132, v9
  v_mul_f32 v133, v133, v9
  v_mfma_f32_16x16x32_bf16 v[16:19], a[72:75], a[120:123], 0
  ds_read_b128 a[120:123], v3 offset:18432
  v_mul_f32 v134, v134, v9
  v_mfma_f32_16x16x32_bf16 v[16:19], a[76:79], a[124:127], v[16:19]
  ds_read_b128 a[124:127], v3 offset:19456
  v_mul_f32 v135, v135, v9
  v_mfma_f32_16x16x32_bf16 v[16:19], a[80:83], a[128:131], v[16:19]
  v_cvt_pk_bf16_f32 v204, v44, v45
  v_cvt_pk_bf16_f32 v205, v46, v47
  v_mfma_f32_16x16x32_bf16 v[16:19], a[84:87], a[132:135], v[16:19]
  ds_read_b128 a[128:131], v3 offset:20480
  ds_read_b128 a[132:135], v3 offset:21504
  v_mfma_f32_16x16x32_bf16 v[16:19], a[88:91], a[136:139], v[16:19]
  ds_read_b128 a[136:139], v3 offset:22528
  v_cvt_pk_bf16_f32 v176, v128, v129
  v_mfma_f32_16x16x32_bf16 v[16:19], a[92:95], a[140:143], v[16:19]
  s_waitcnt lgkmcnt(5)
  ds_read_b128 a[140:143], v3 offset:23552
  v_cvt_pk_bf16_f32 v177, v130, v131
  v_mfma_f32_16x16x32_bf16 v[20:23], a[0:3], a[96:99], 0
  v_cvt_pk_bf16_f32 v178, v132, v133
  v_cvt_pk_bf16_f32 v179, v134, v135
  v_mfma_f32_16x16x32_bf16 v[20:23], a[4:7], a[100:103], v[20:23]
  v_permlane32_swap_b32 v11, v12
  v_mfma_f32_16x16x32_bf16 v[20:23], a[8:11], a[104:107], v[20:23]
  v_cvt_pk_bf16_f32 v206, v16, v17
  v_cvt_pk_bf16_f32 v207, v18, v19
  v_mfma_f32_16x16x32_bf16 v[20:23], a[12:15], a[108:111], v[20:23]
  v_mul_f32 v136, v136, v9
  v_mul_f32 v137, v137, v9
  v_mfma_f32_16x16x32_bf16 v[20:23], a[16:19], a[112:115], v[20:23]
  v_mul_f32 v138, v138, v9
  v_mul_f32 v139, v139, v9
  v_mfma_f32_16x16x32_bf16 v[20:23], a[20:23], a[116:119], v[20:23]
  v_mul_f32 v140, v140, v9
  v_mul_f32 v141, v141, v9
  v_mfma_f32_16x16x32_bf16 v[24:27], a[24:27], a[96:99], 0
  v_mul_f32 v142, v142, v9
  v_mul_f32 v143, v143, v9
  v_mfma_f32_16x16x32_bf16 v[24:27], a[28:31], a[100:103], v[24:27]
  v_max_f32 v11, v11, v12
  v_cvt_pk_bf16_f32 v180, v136, v137
  v_mfma_f32_16x16x32_bf16 v[24:27], a[32:35], a[104:107], v[24:27]
  v_cvt_pk_bf16_f32 v48, v20, v21
  v_cvt_pk_bf16_f32 v49, v22, v23
  v_mfma_f32_16x16x32_bf16 v[24:27], a[36:39], a[108:111], v[24:27]
  v_cvt_pk_bf16_f32 v181, v138, v139
  v_cvt_pk_bf16_f32 v182, v140, v141
  v_mfma_f32_16x16x32_bf16 v[24:27], a[40:43], a[112:115], v[24:27]
  v_cvt_pk_bf16_f32 v183, v142, v143
  v_mov_b32 v12, v11
  v_mfma_f32_16x16x32_bf16 v[24:27], a[44:47], a[116:119], v[24:27]
  v_mfma_f32_16x16x32_bf16 v[28:31], v[192:195], v[160:163], 0
  v_permlane16_swap_b32 v11, v12
  v_mfma_f32_16x16x32_bf16 v[28:31], v[196:199], v[164:167], v[28:31]
  v_max_f32 v11, v11, v12
  v_sub_f32 v144, v144, v11
  v_mfma_f32_16x16x32_bf16 v[32:35], v[200:203], v[160:163], 0
  v_sub_f32 v145, v145, v11
  v_sub_f32 v146, v146, v11
  v_mfma_f32_16x16x32_bf16 v[32:35], v[204:207], v[164:167], v[32:35]
  v_cvt_pk_bf16_f32 v50, v24, v25
  v_cvt_pk_bf16_f32 v51, v26, v27
  v_mfma_f32_16x16x32_bf16 v[36:39], a[48:51], a[96:99], 0
  v_cvt_pk_bf16_f32 v240, v28, v29
  v_cvt_pk_bf16_f32 v241, v30, v31
  v_mfma_f32_16x16x32_bf16 v[36:39], a[52:55], a[100:103], v[36:39]
  v_exp_f32 v144, v144
  v_mfma_f32_16x16x32_bf16 v[36:39], a[56:59], a[104:107], v[36:39]
  v_cvt_pk_bf16_f32 v242, v32, v33
  v_cvt_pk_bf16_f32 v243, v34, v35
  v_mfma_f32_16x16x32_bf16 v[36:39], a[60:63], a[108:111], v[36:39]
  buffer_store_dwordx4 v[240:243], v1, s[12:15], s44 offen offset:0 sc1 nt
  v_exp_f32 v145, v145
  v_mfma_f32_16x16x32_bf16 v[36:39], a[64:67], a[112:115], v[36:39]
  v_exp_f32 v146, v146
  v_mfma_f32_16x16x32_bf16 v[36:39], a[68:71], a[116:119], v[36:39]
  v_sub_f32 v147, v147, v11
  v_sub_f32 v148, v148, v11
  v_mfma_f32_16x16x32_bf16 v[40:43], a[72:75], a[96:99], 0
  ds_read_b128 a[96:99], v3 offset:24576
  v_add_f32 v13, v144, v145
  v_mfma_f32_16x16x32_bf16 v[40:43], a[76:79], a[100:103], v[40:43]
  ds_read_b128 a[100:103], v3 offset:25600
  v_sub_f32 v149, v149, v11
  v_mfma_f32_16x16x32_bf16 v[40:43], a[80:83], a[104:107], v[40:43]
  ds_read_b128 a[104:107], v3 offset:26624
  v_cvt_pk_bf16_f32 v52, v36, v37
  v_mfma_f32_16x16x32_bf16 v[40:43], a[84:87], a[108:111], v[40:43]
  ds_read_b128 a[108:111], v3 offset:27648
  v_cvt_pk_bf16_f32 v53, v38, v39
  v_mfma_f32_16x16x32_bf16 v[40:43], a[88:91], a[112:115], v[40:43]
  ds_read_b128 a[112:115], v3 offset:28672
  v_add_f32 v13, v13, v146
  v_mfma_f32_16x16x32_bf16 v[40:43], a[92:95], a[116:119], v[40:43]
  ds_read_b128 a[116:119], v3 offset:29696
  v_sub_f32 v150, v150, v11
  v_mfma_f32_16x16x32_bf16 v[44:47], v[192:195], v[168:171], 0
  v_exp_f32 v147, v147
  v_mfma_f32_16x16x32_bf16 v[44:47], v[196:199], v[172:175], v[44:47]
  v_exp_f32 v148, v148
  v_mfma_f32_16x16x32_bf16 v[16:19], v[200:203], v[168:171], 0
  v_exp_f32 v149, v149
  v_mfma_f32_16x16x32_bf16 v[16:19], v[204:207], v[172:175], v[16:19]
  s_waitcnt lgkmcnt(6)
  v_cvt_pk_bf16_f32 v54, v40, v41
  v_cvt_pk_bf16_f32 v55, v42, v43
  v_mfma_f32_16x16x32_bf16 v[20:23], a[0:3], a[120:123], 0
  v_cvt_pk_bf16_f32 v244, v44, v45
L_pad2:
  s_cbranch_execz L_pad3
  v_cvt_pk_bf16_f32 v245, v46, v47
  v_mfma_f32_16x16x32_bf16 v[20:23], a[4:7], a[124:127], v[20:23]
  v_add_f32 v13, v13, v147
  v_cvt_pk_bf16_f32 v246, v16, v17
  v_mfma_f32_16x16x32_bf16 v[20:23], a[8:11], a[128:131], v[20:23]
  v_cvt_pk_bf16_f32 v247, v18, v19
  v_sub_f32 v151, v151, v11
  v_mfma_f32_16x16x32_bf16 v[20:23], a[12:15], a[132:135], v[20:23]
  buffer_store_dwordx4 v[244:247], v1, s[12:15], s45 offen offset:0 sc1 nt
  v_exp_f32 v150, v150
  v_mfma_f32_16x16x32_bf16 v[20:23], a[16:19], a[136:139], v[20:23]
  v_add_f32 v13, v13, v148
  v_sub_f32 v152, v152, v11
  v_mfma_f32_16x16x32_bf16 v[20:23], a[20:23], a[140:143], v[20:23]
  v_exp_f32 v151, v151
  v_mfma_f32_16x16x32_bf16 v[24:27], a[24:27], a[120:123], 0
  v_add_f32 v13, v13, v149
  v_sub_f32 v153, v153, v11
  v_mfma_f32_16x16x32_bf16 v[24:27], a[28:31], a[124:127], v[24:27]
  v_exp_f32 v152, v152
  v_mfma_f32_16x16x32_bf16 v[24:27], a[32:35], a[128:131], v[24:27]
  v_add_f32 v13, v13, v150
  v_sub_f32 v154, v154, v11
  v_mfma_f32_16x16x32_bf16 v[24:27], a[36:39], a[132:135], v[24:27]
  v_exp_f32 v153, v153
  v_mfma_f32_16x16x32_bf16 v[24:27], a[40:43], a[136:139], v[24:27]
  v_add_f32 v13, v13, v151
  v_sub_f32 v155, v155, v11
  v_mfma_f32_16x16x32_bf16 v[24:27], a[44:47], a[140:143], v[24:27]
  v_exp_f32 v154, v154
  v_mfma_f32_16x16x32_bf16 v[28:31], a[48:51], a[120:123], 0
  v_add_f32 v13, v13, v152
  v_sub_f32 v156, v156, v11
  v_mfma_f32_16x16x32_bf16 v[28:31], a[52:55], a[124:127], v[28:31]
  v_exp_f32 v155, v155
  v_mfma_f32_16x16x32_bf16 v[28:31], a[56:59], a[128:131], v[28:31]
  v_add_f32 v13, v13, v153
  v_sub_f32 v157, v157, v11
  v_mfma_f32_16x16x32_bf16 v[28:31], a[60:63], a[132:135], v[28:31]
  v_exp_f32 v156, v156
  v_mfma_f32_16x16x32_bf16 v[28:31], a[64:67], a[136:139], v[28:31]
  v_add_f32 v13, v13, v154
  v_sub_f32 v158, v158, v11
  v_mfma_f32_16x16x32_bf16 v[28:31], a[68:71], a[140:143], v[28:31]
  v_exp_f32 v157, v157
  v_mfma_f32_16x16x32_bf16 v[32:35], a[72:75], a[120:123], 0
  v_add_f32 v13, v13, v155
  v_sub_f32 v159, v159, v11
  v_mfma_f32_16x16x32_bf16 v[32:35], a[76:79], a[124:127], v[32:35]
  v_exp_f32 v158, v158
  v_mfma_f32_16x16x32_bf16 v[32:35], a[80:83], a[128:131], v[32:35]
  v_add_f32 v13, v13, v156
  v_cvt_pk_bf16_f32 v56, v20, v21
  v_mfma_f32_16x16x32_bf16 v[32:35], a[84:87], a[132:135], v[32:35]
  v_exp_f32 v159, v159
  v_mfma_f32_16x16x32_bf16 v[32:35], a[88:91], a[136:139], v[32:35]
  v_cvt_pk_bf16_f32 v57, v22, v23
  v_add_f32 v13, v13, v157
  v_mfma_f32_16x16x32_bf16 v[32:35], a[92:95], a[140:143], v[32:35]
  s_waitcnt lgkmcnt(0)
  v_add_f32 v13, v13, v158
  v_cvt_pk_bf16_f32 v58, v24, v25
  v_mfma_f32_16x16x32_bf16 v[36:39], a[0:3], a[96:99], 0
  v_cvt_pk_bf16_f32 v59, v26, v27
  v_add_f32 v13, v13, v159
  v_mfma_f32_16x16x32_bf16 v[36:39], a[4:7], a[100:103], v[36:39]
  v_mov_b32 v14, v13
  v_cvt_pk_bf16_f32 v60, v28, v29
  v_mfma_f32_16x16x32_bf16 v[36:39], a[8:11], a[104:107], v[36:39]
  v_cvt_pk_bf16_f32 v61, v30, v31
  v_cvt_pk_bf16_f32 v62, v32, v33
  v_mfma_f32_16x16x32_bf16 v[36:39], a[12:15], a[108:111], v[36:39]
  ds_read_b128 a[120:123], v3 offset:30720
  v_cvt_pk_bf16_f32 v63, v34, v35
  v_mfma_f32_16x16x32_bf16 v[36:39], a[16:19], a[112:115], v[36:39]
  v_permlane32_swap_b32 v13, v14
  v_mfma_f32_16x16x32_bf16 v[36:39], a[20:23], a[116:119], v[36:39]
  ds_read_b128 a[124:127], v3 offset:31744
  v_add_f32 v13, v13, v14
  v_mfma_f32_16x16x32_bf16 v[40:43], v[192:195], v[176:179], 0
  ds_read_b128 a[128:131], v3 offset:32768
  v_mov_b32 v14, v13
  v_mfma_f32_16x16x32_bf16 v[40:43], v[196:199], v[180:183], v[40:43]
  ds_read_b128 a[132:135], v3 offset:33792
  ds_read_b128 a[136:139], v3 offset:34816
  v_mfma_f32_16x16x32_bf16 v[44:47], v[200:203], v[176:179], 0
  v_permlane16_swap_b32 v13, v14
  v_mfma_f32_16x16x32_bf16 v[44:47], v[204:207], v[180:183], v[44:47]
  v_add_f32 v13, v13, v14
  v_cvt_pk_bf16_f32 v208, v36, v37
  v_mfma_f32_16x16x32_bf16 v[16:19], a[24:27], a[96:99], 0
  v_cvt_pk_bf16_f32 v248, v40, v41
  v_cvt_pk_bf16_f32 v249, v42, v43
  v_mfma_f32_16x16x32_bf16 v[16:19], a[28:31], a[100:103], v[16:19]
  v_rcp_f32 v13, v13
  v_mfma_f32_16x16x32_bf16 v[16:19], a[32:35], a[104:107], v[16:19]
  v_cvt_pk_bf16_f32 v250, v44, v45
  v_cvt_pk_bf16_f32 v251, v46, v47
  v_mfma_f32_16x16x32_bf16 v[16:19], a[36:39], a[108:111], v[16:19]
  buffer_store_dwordx4 v[248:251], v1, s[72:75], s46 offen offset:0 sc1 nt
  v_mul_f32 v144, v144, v13
  v_mul_f32 v145, v145, v13
  v_mfma_f32_16x16x32_bf16 v[16:19], a[40:43], a[112:115], v[16:19]
  v_mul_f32 v146, v146, v13
  v_mul_f32 v147, v147, v13
  v_mfma_f32_16x16x32_bf16 v[16:19], a[44:47], a[116:119], v[16:19]
  v_mul_f32 v148, v148, v13
  v_mul_f32 v149, v149, v13
  v_mfma_f32_16x16x32_bf16 v[20:23], v[48:51], v[160:163], 0
  v_mul_f32 v150, v150, v13
  v_mul_f32 v151, v151, v13
  v_mfma_f32_16x16x32_bf16 v[20:23], v[52:55], v[164:167], v[20:23]
  v_cvt_pk_bf16_f32 v184, v144, v145
  v_cvt_pk_bf16_f32 v185, v146, v147
  v_mfma_f32_16x16x32_bf16 v[24:27], v[56:59], v[160:163], 0
  v_cvt_pk_bf16_f32 v186, v148, v149
  v_cvt_pk_bf16_f32 v187, v150, v151
  v_mfma_f32_16x16x32_bf16 v[24:27], v[60:63], v[164:167], v[24:27]
  v_mul_f32 v152, v152, v13
  v_mul_f32 v153, v153, v13
  v_mfma_f32_16x16x32_bf16 v[28:31], a[48:51], a[96:99], 0
  v_cvt_pk_bf16_f32 v252, v20, v21
  v_cvt_pk_bf16_f32 v253, v22, v23
  v_mfma_f32_16x16x32_bf16 v[28:31], a[52:55], a[100:103], v[28:31]
  v_mul_f32 v154, v154, v13
  v_mul_f32 v155, v155, v13
  v_mfma_f32_16x16x32_bf16 v[28:31], a[56:59], a[104:107], v[28:31]
  v_cvt_pk_bf16_f32 v254, v24, v25
  v_cvt_pk_bf16_f32 v255, v26, v27
  v_mfma_f32_16x16x32_bf16 v[28:31], a[60:63], a[108:111], v[28:31]
  buffer_store_dwordx4 v[252:255], v1, s[12:15], s44 offen offset:64 sc1 nt
  v_mul_f32 v156, v156, v13
  v_mul_f32 v157, v157, v13
  v_mfma_f32_16x16x32_bf16 v[28:31], a[64:67], a[112:115], v[28:31]
  v_mul_f32 v158, v158, v13
  v_mul_f32 v159, v159, v13
  v_mfma_f32_16x16x32_bf16 v[28:31], a[68:71], a[116:119], v[28:31]
  v_cvt_pk_bf16_f32 v188, v152, v153
  v_cvt_pk_bf16_f32 v189, v154, v155
  v_mfma_f32_16x16x32_bf16 v[32:35], v[192:195], v[184:187], 0
  v_cvt_pk_bf16_f32 v190, v156, v157
  v_cvt_pk_bf16_f32 v191, v158, v159
  v_cvt_pk_bf16_f32 v209, v38, v39
  ds_read_b128 a[140:143], v3 offset:35840
  v_mfma_f32_16x16x32_bf16 v[32:35], v[196:199], v[188:191], v[32:35]
  v_cvt_pk_bf16_f32 v210, v16, v17
  v_cvt_pk_bf16_f32 v211, v18, v19
  v_mfma_f32_16x16x32_bf16 v[36:39], v[200:203], v[184:187], 0
  v_cvt_pk_bf16_f32 v212, v28, v29
  v_cvt_pk_bf16_f32 v213, v30, v31
  v_mfma_f32_16x16x32_bf16 v[36:39], v[204:207], v[188:191], v[36:39]
  s_nop 1
  v_cvt_pk_bf16_f32 v240, v32, v33
  v_mfma_f32_16x16x32_bf16 v[40:43], a[72:75], a[96:99], 0
  ds_read_b128 a[96:99], v3 offset:36864
  v_cvt_pk_bf16_f32 v241, v34, v35
  v_mfma_f32_16x16x32_bf16 v[40:43], a[76:79], a[100:103], v[40:43]
  ds_read_b128 a[100:103], v3 offset:37888
  v_cvt_pk_bf16_f32 v242, v36, v37
  v_mfma_f32_16x16x32_bf16 v[40:43], a[80:83], a[104:107], v[40:43]
  ds_read_b128 a[104:107], v3 offset:38912
  v_cvt_pk_bf16_f32 v243, v38, v39
  v_mfma_f32_16x16x32_bf16 v[40:43], a[84:87], a[108:111], v[40:43]
  buffer_store_dwordx4 v[240:243], v1, s[72:75], s47 offen offset:0 sc1 nt
  ds_read_b128 a[108:111], v3 offset:39936
  v_mfma_f32_16x16x32_bf16 v[40:43], a[88:91], a[112:115], v[40:43]
  ds_read_b128 a[112:115], v3 offset:40960
  v_mfma_f32_16x16x32_bf16 v[40:43], a[92:95], a[116:119], v[40:43]
  ds_read_b128 a[116:119], v3 offset:41984
  v_mfma_f32_16x16x32_bf16 v[44:47], v[48:51], v[168:171], 0
  v_mfma_f32_16x16x32_bf16 v[44:47], v[52:55], v[172:175], v[44:47]
  s_nop 2
  v_mfma_f32_16x16x32_bf16 v[16:19], v[56:59], v[168:171], 0
  s_nop 2
  v_mfma_f32_16x16x32_bf16 v[16:19], v[60:63], v[172:175], v[16:19]
  s_waitcnt lgkmcnt(6)
  v_cvt_pk_bf16_f32 v244, v44, v45
  v_cvt_pk_bf16_f32 v245, v46, v47
  v_mfma_f32_16x16x32_bf16 v[20:23], a[0:3], a[120:123], 0
  v_cvt_pk_bf16_f32 v214, v40, v41
  v_cvt_pk_bf16_f32 v215, v42, v43
  v_mfma_f32_16x16x32_bf16 v[20:23], a[4:7], a[124:127], v[20:23]
  s_nop 0
  v_cvt_pk_bf16_f32 v246, v16, v17
  v_mfma_f32_16x16x32_bf16 v[20:23], a[8:11], a[128:131], v[20:23]
  v_cvt_pk_bf16_f32 v247, v18, v19
  v_mfma_f32_16x16x32_bf16 v[20:23], a[12:15], a[132:135], v[20:23]
  buffer_store_dwordx4 v[244:247], v1, s[12:15], s45 offen offset:64 sc1 nt
  v_mfma_f32_16x16x32_bf16 v[20:23], a[16:19], a[136:139], v[20:23]
  v_mfma_f32_16x16x32_bf16 v[20:23], a[20:23], a[140:143], v[20:23]
  v_mfma_f32_16x16x32_bf16 v[24:27], v[48:51], v[176:179], 0
  v_mfma_f32_16x16x32_bf16 v[24:27], v[52:55], v[180:183], v[24:27]
  s_nop 2
  v_mfma_f32_16x16x32_bf16 v[28:31], v[56:59], v[176:179], 0
  s_nop 2
  v_mfma_f32_16x16x32_bf16 v[28:31], v[60:63], v[180:183], v[28:31]
  v_cvt_pk_bf16_f32 v248, v24, v25
  v_cvt_pk_bf16_f32 v249, v26, v27
  v_mfma_f32_16x16x32_bf16 v[32:35], a[24:27], a[120:123], 0
  v_cvt_pk_bf16_f32 v216, v20, v21
  v_cvt_pk_bf16_f32 v217, v22, v23
  v_mfma_f32_16x16x32_bf16 v[32:35], a[28:31], a[124:127], v[32:35]
  s_nop 1
  v_cvt_pk_bf16_f32 v250, v28, v29
  v_mfma_f32_16x16x32_bf16 v[32:35], a[32:35], a[128:131], v[32:35]
  v_cvt_pk_bf16_f32 v251, v30, v31
  v_mfma_f32_16x16x32_bf16 v[32:35], a[36:39], a[132:135], v[32:35]
  buffer_store_dwordx4 v[248:251], v1, s[72:75], s46 offen offset:64 sc1 nt
  v_mfma_f32_16x16x32_bf16 v[32:35], a[40:43], a[136:139], v[32:35]
  v_mfma_f32_16x16x32_bf16 v[32:35], a[44:47], a[140:143], v[32:35]
  v_mfma_f32_16x16x32_bf16 v[36:39], a[48:51], a[120:123], 0
  v_mfma_f32_16x16x32_bf16 v[36:39], a[52:55], a[124:127], v[36:39]
  v_mfma_f32_16x16x32_bf16 v[36:39], a[56:59], a[128:131], v[36:39]
  v_mfma_f32_16x16x32_bf16 v[36:39], a[60:63], a[132:135], v[36:39]
  v_mfma_f32_16x16x32_bf16 v[36:39], a[64:67], a[136:139], v[36:39]
  v_mfma_f32_16x16x32_bf16 v[36:39], a[68:71], a[140:143], v[36:39]
  v_mfma_f32_16x16x32_bf16 v[40:43], v[48:51], v[184:187], 0
  v_mfma_f32_16x16x32_bf16 v[40:43], v[52:55], v[188:191], v[40:43]
  v_cvt_pk_bf16_f32 v218, v32, v33
  v_cvt_pk_bf16_f32 v219, v34, v35
  v_mfma_f32_16x16x32_bf16 v[44:47], v[56:59], v[184:187], 0
  s_nop 2
  v_mfma_f32_16x16x32_bf16 v[44:47], v[60:63], v[188:191], v[44:47]
  v_cvt_pk_bf16_f32 v220, v36, v37
  v_cvt_pk_bf16_f32 v252, v40, v41
  v_mfma_f32_16x16x32_bf16 v[16:19], a[72:75], a[120:123], 0
  v_cvt_pk_bf16_f32 v253, v42, v43
  v_cvt_pk_bf16_f32 v221, v38, v39
  v_mfma_f32_16x16x32_bf16 v[16:19], a[76:79], a[124:127], v[16:19]
  ds_read_b128 a[120:123], v3 offset:43008
  ds_read_b128 a[124:127], v3 offset:44032
  v_mfma_f32_16x16x32_bf16 v[16:19], a[80:83], a[128:131], v[16:19]
  v_cvt_pk_bf16_f32 v254, v44, v45
  v_cvt_pk_bf16_f32 v255, v46, v47
  v_mfma_f32_16x16x32_bf16 v[16:19], a[84:87], a[132:135], v[16:19]
  buffer_store_dwordx4 v[252:255], v1, s[72:75], s47 offen offset:64 sc1 nt
  ds_read_b128 a[128:131], v3 offset:45056
  ds_read_b128 a[132:135], v3 offset:46080
  v_mfma_f32_16x16x32_bf16 v[16:19], a[88:91], a[136:139], v[16:19]
  ds_read_b128 a[136:139], v3 offset:47104
  v_mfma_f32_16x16x32_bf16 v[16:19], a[92:95], a[140:143], v[16:19]
  s_waitcnt lgkmcnt(5)
  ds_read_b128 a[140:143], v3 offset:48128
  v_mfma_f32_16x16x32_bf16 v[20:23], a[0:3], a[96:99], 0
  v_mfma_f32_16x16x32_bf16 v[20:23], a[4:7], a[100:103], v[20:23]
  v_mfma_f32_16x16x32_bf16 v[20:23], a[8:11], a[104:107], v[20:23]
  v_mfma_f32_16x16x32_bf16 v[20:23], a[12:15], a[108:111], v[20:23]
  v_mfma_f32_16x16x32_bf16 v[20:23], a[16:19], a[112:115], v[20:23]
  v_mfma_f32_16x16x32_bf16 v[20:23], a[20:23], a[116:119], v[20:23]
  v_cvt_pk_bf16_f32 v222, v16, v17
  v_cvt_pk_bf16_f32 v223, v18, v19
  v_mfma_f32_16x16x32_bf16 v[24:27], a[24:27], a[96:99], 0
  v_mfma_f32_16x16x32_bf16 v[24:27], a[28:31], a[100:103], v[24:27]
  v_mfma_f32_16x16x32_bf16 v[24:27], a[32:35], a[104:107], v[24:27]
  v_mfma_f32_16x16x32_bf16 v[24:27], a[36:39], a[108:111], v[24:27]
  v_mfma_f32_16x16x32_bf16 v[24:27], a[40:43], a[112:115], v[24:27]
  v_mfma_f32_16x16x32_bf16 v[24:27], a[44:47], a[116:119], v[24:27]
  v_cvt_pk_bf16_f32 v64, v20, v21
  v_cvt_pk_bf16_f32 v65, v22, v23
  v_mfma_f32_16x16x32_bf16 v[28:31], v[208:211], v[160:163], 0
  v_mfma_f32_16x16x32_bf16 v[28:31], v[212:215], v[164:167], v[28:31]
  s_nop 2
  v_mfma_f32_16x16x32_bf16 v[32:35], v[216:219], v[160:163], 0
  v_cvt_pk_bf16_f32 v66, v24, v25
  v_cvt_pk_bf16_f32 v67, v26, v27
  v_mfma_f32_16x16x32_bf16 v[32:35], v[220:223], v[164:167], v[32:35]
  s_nop 0
  v_cvt_pk_bf16_f32 v240, v28, v29
  v_mfma_f32_16x16x32_bf16 v[36:39], a[48:51], a[96:99], 0
  v_cvt_pk_bf16_f32 v241, v30, v31
  s_nop 0
  v_mfma_f32_16x16x32_bf16 v[36:39], a[52:55], a[100:103], v[36:39]
  s_nop 1
  v_cvt_pk_bf16_f32 v242, v32, v33
  v_mfma_f32_16x16x32_bf16 v[36:39], a[56:59], a[104:107], v[36:39]
  v_cvt_pk_bf16_f32 v243, v34, v35
  v_mfma_f32_16x16x32_bf16 v[36:39], a[60:63], a[108:111], v[36:39]
  buffer_store_dwordx4 v[240:243], v1, s[12:15], s44 offen offset:128 sc1 nt
  v_mfma_f32_16x16x32_bf16 v[36:39], a[64:67], a[112:115], v[36:39]
  v_mfma_f32_16x16x32_bf16 v[36:39], a[68:71], a[116:119], v[36:39]
  v_mfma_f32_16x16x32_bf16 v[40:43], v[208:211], v[176:179], 0
  v_mfma_f32_16x16x32_bf16 v[40:43], v[212:215], v[180:183], v[40:43]
  s_nop 2
  v_mfma_f32_16x16x32_bf16 v[44:47], v[216:219], v[176:179], 0
  s_nop 2
  v_mfma_f32_16x16x32_bf16 v[44:47], v[220:223], v[180:183], v[44:47]
  v_cvt_pk_bf16_f32 v244, v40, v41
  v_cvt_pk_bf16_f32 v245, v42, v43
  v_mfma_f32_16x16x32_bf16 v[16:19], a[72:75], a[96:99], 0
  v_cvt_pk_bf16_f32 v68, v36, v37
  v_cvt_pk_bf16_f32 v69, v38, v39
  v_mfma_f32_16x16x32_bf16 v[16:19], a[76:79], a[100:103], v[16:19]
  ds_read_b128 a[96:99], v3 offset:49152
  ds_read_b128 a[100:103], v3 offset:50176
  v_mfma_f32_16x16x32_bf16 v[16:19], a[80:83], a[104:107], v[16:19]
  v_cvt_pk_bf16_f32 v246, v44, v45
  v_cvt_pk_bf16_f32 v247, v46, v47
  v_mfma_f32_16x16x32_bf16 v[16:19], a[84:87], a[108:111], v[16:19]
  buffer_store_dwordx4 v[244:247], v1, s[72:75], s46 offen offset:128 sc1 nt
  ds_read_b128 a[104:107], v3 offset:51200
  ds_read_b128 a[108:111], v3 offset:52224
  v_mfma_f32_16x16x32_bf16 v[16:19], a[88:91], a[112:115], v[16:19]
  ds_read_b128 a[112:115], v3 offset:53248
  v_mfma_f32_16x16x32_bf16 v[16:19], a[92:95], a[116:119], v[16:19]
  ds_read_b128 a[116:119], v3 offset:54272
  v_mfma_f32_16x16x32_bf16 v[20:23], v[208:211], v[168:171], 0
  v_mfma_f32_16x16x32_bf16 v[20:23], v[212:215], v[172:175], v[20:23]
  s_nop 2
  v_mfma_f32_16x16x32_bf16 v[24:27], v[216:219], v[168:171], 0
  s_nop 2
  v_mfma_f32_16x16x32_bf16 v[24:27], v[220:223], v[172:175], v[24:27]
  s_waitcnt lgkmcnt(6)
  v_cvt_pk_bf16_f32 v248, v20, v21
  v_cvt_pk_bf16_f32 v249, v22, v23
  v_mfma_f32_16x16x32_bf16 v[28:31], a[0:3], a[120:123], 0
  v_cvt_pk_bf16_f32 v70, v16, v17
  v_cvt_pk_bf16_f32 v71, v18, v19
  v_mfma_f32_16x16x32_bf16 v[28:31], a[4:7], a[124:127], v[28:31]
  s_nop 0
  v_cvt_pk_bf16_f32 v250, v24, v25
  v_mfma_f32_16x16x32_bf16 v[28:31], a[8:11], a[128:131], v[28:31]
  v_cvt_pk_bf16_f32 v251, v26, v27
  v_mfma_f32_16x16x32_bf16 v[28:31], a[12:15], a[132:135], v[28:31]
  buffer_store_dwordx4 v[248:251], v1, s[12:15], s45 offen offset:128 sc1 nt
  v_mfma_f32_16x16x32_bf16 v[28:31], a[16:19], a[136:139], v[28:31]
  v_mfma_f32_16x16x32_bf16 v[28:31], a[20:23], a[140:143], v[28:31]
  v_mfma_f32_16x16x32_bf16 v[32:35], v[208:211], v[184:187], 0
  v_mfma_f32_16x16x32_bf16 v[32:35], v[212:215], v[188:191], v[32:35]
  s_nop 2
  v_mfma_f32_16x16x32_bf16 v[36:39], v[216:219], v[184:187], 0
  s_nop 2
  v_mfma_f32_16x16x32_bf16 v[36:39], v[220:223], v[188:191], v[36:39]
  v_cvt_pk_bf16_f32 v252, v32, v33
  v_cvt_pk_bf16_f32 v253, v34, v35
  v_mfma_f32_16x16x32_bf16 v[40:43], a[24:27], a[120:123], 0
  v_cvt_pk_bf16_f32 v72, v28, v29
  v_cvt_pk_bf16_f32 v73, v30, v31
  v_mfma_f32_16x16x32_bf16 v[40:43], a[28:31], a[124:127], v[40:43]
  s_nop 1
  v_cvt_pk_bf16_f32 v254, v36, v37
  v_mfma_f32_16x16x32_bf16 v[40:43], a[32:35], a[128:131], v[40:43]
  v_cvt_pk_bf16_f32 v255, v38, v39
  v_mfma_f32_16x16x32_bf16 v[40:43], a[36:39], a[132:135], v[40:43]
  buffer_store_dwordx4 v[252:255], v1, s[72:75], s47 offen offset:128 sc1 nt
  v_mfma_f32_16x16x32_bf16 v[40:43], a[40:43], a[136:139], v[40:43]
  v_mfma_f32_16x16x32_bf16 v[40:43], a[44:47], a[140:143], v[40:43]
  v_mfma_f32_16x16x32_bf16 v[44:47], a[48:51], a[120:123], 0
  v_mfma_f32_16x16x32_bf16 v[44:47], a[52:55], a[124:127], v[44:47]
  v_mfma_f32_16x16x32_bf16 v[44:47], a[56:59], a[128:131], v[44:47]
  v_mfma_f32_16x16x32_bf16 v[44:47], a[60:63], a[132:135], v[44:47]
  v_mfma_f32_16x16x32_bf16 v[44:47], a[64:67], a[136:139], v[44:47]
  v_mfma_f32_16x16x32_bf16 v[44:47], a[68:71], a[140:143], v[44:47]
  v_mfma_f32_16x16x32_bf16 v[16:19], a[72:75], a[120:123], 0
  ds_read_b128 a[120:123], v3 offset:55296
  v_cvt_pk_bf16_f32 v74, v40, v41
  v_mfma_f32_16x16x32_bf16 v[16:19], a[76:79], a[124:127], v[16:19]
  ds_read_b128 a[124:127], v3 offset:56320
  v_cvt_pk_bf16_f32 v75, v42, v43
  v_mfma_f32_16x16x32_bf16 v[16:19], a[80:83], a[128:131], v[16:19]
  ds_read_b128 a[128:131], v3 offset:57344
  v_cvt_pk_bf16_f32 v76, v44, v45
  v_mfma_f32_16x16x32_bf16 v[16:19], a[84:87], a[132:135], v[16:19]
  ds_read_b128 a[132:135], v3 offset:58368
  v_cvt_pk_bf16_f32 v77, v46, v47
  v_mfma_f32_16x16x32_bf16 v[16:19], a[88:91], a[136:139], v[16:19]
  ds_read_b128 a[136:139], v3 offset:59392
  v_mfma_f32_16x16x32_bf16 v[16:19], a[92:95], a[140:143], v[16:19]
  s_waitcnt lgkmcnt(5)
  ds_read_b128 a[140:143], v3 offset:60416
  v_mfma_f32_16x16x32_bf16 v[20:23], a[0:3], a[96:99], 0
  v_mfma_f32_16x16x32_bf16 v[20:23], a[4:7], a[100:103], v[20:23]
  v_mfma_f32_16x16x32_bf16 v[20:23], a[8:11], a[104:107], v[20:23]
  v_mfma_f32_16x16x32_bf16 v[20:23], a[12:15], a[108:111], v[20:23]
  v_mfma_f32_16x16x32_bf16 v[20:23], a[16:19], a[112:115], v[20:23]
  v_mfma_f32_16x16x32_bf16 v[20:23], a[20:23], a[116:119], v[20:23]
  v_cvt_pk_bf16_f32 v78, v16, v17
  v_cvt_pk_bf16_f32 v79, v18, v19
  v_mfma_f32_16x16x32_bf16 v[24:27], a[24:27], a[96:99], 0
  v_mfma_f32_16x16x32_bf16 v[24:27], a[28:31], a[100:103], v[24:27]
  v_mfma_f32_16x16x32_bf16 v[24:27], a[32:35], a[104:107], v[24:27]
  v_mfma_f32_16x16x32_bf16 v[24:27], a[36:39], a[108:111], v[24:27]
  v_mfma_f32_16x16x32_bf16 v[24:27], a[40:43], a[112:115], v[24:27]
  v_mfma_f32_16x16x32_bf16 v[24:27], a[44:47], a[116:119], v[24:27]
  v_cvt_pk_bf16_f32 v224, v20, v21
  v_cvt_pk_bf16_f32 v225, v22, v23
  v_mfma_f32_16x16x32_bf16 v[28:31], v[64:67], v[160:163], 0
  v_mfma_f32_16x16x32_bf16 v[28:31], v[68:71], v[164:167], v[28:31]
  s_nop 2
  v_mfma_f32_16x16x32_bf16 v[32:35], v[72:75], v[160:163], 0
  v_cvt_pk_bf16_f32 v226, v24, v25
  v_cvt_pk_bf16_f32 v227, v26, v27
  v_mfma_f32_16x16x32_bf16 v[32:35], v[76:79], v[164:167], v[32:35]
  s_nop 0
  v_cvt_pk_bf16_f32 v240, v28, v29
  v_mfma_f32_16x16x32_bf16 v[36:39], a[48:51], a[96:99], 0
  v_cvt_pk_bf16_f32 v241, v30, v31
  s_nop 0
  v_mfma_f32_16x16x32_bf16 v[36:39], a[52:55], a[100:103], v[36:39]
  s_nop 1
  v_cvt_pk_bf16_f32 v242, v32, v33
  v_mfma_f32_16x16x32_bf16 v[36:39], a[56:59], a[104:107], v[36:39]
  v_cvt_pk_bf16_f32 v243, v34, v35
  v_mfma_f32_16x16x32_bf16 v[36:39], a[60:63], a[108:111], v[36:39]
  buffer_store_dwordx4 v[240:243], v1, s[12:15], s44 offen offset:192 sc1 nt
  v_mfma_f32_16x16x32_bf16 v[36:39], a[64:67], a[112:115], v[36:39]
  v_mfma_f32_16x16x32_bf16 v[36:39], a[68:71], a[116:119], v[36:39]
  v_mfma_f32_16x16x32_bf16 v[40:43], v[64:67], v[176:179], 0
  v_mfma_f32_16x16x32_bf16 v[40:43], v[68:71], v[180:183], v[40:43]
  s_nop 2
  v_mfma_f32_16x16x32_bf16 v[44:47], v[72:75], v[176:179], 0
  s_nop 2
  v_mfma_f32_16x16x32_bf16 v[44:47], v[76:79], v[180:183], v[44:47]
  v_cvt_pk_bf16_f32 v244, v40, v41
  v_cvt_pk_bf16_f32 v245, v42, v43
  v_mfma_f32_16x16x32_bf16 v[16:19], a[72:75], a[96:99], 0
  v_cvt_pk_bf16_f32 v228, v36, v37
  v_cvt_pk_bf16_f32 v229, v38, v39
  v_mfma_f32_16x16x32_bf16 v[16:19], a[76:79], a[100:103], v[16:19]
  ds_read_b128 a[96:99], v3 offset:61440
  ds_read_b128 a[100:103], v3 offset:62464
  v_mfma_f32_16x16x32_bf16 v[16:19], a[80:83], a[104:107], v[16:19]
  v_cvt_pk_bf16_f32 v246, v44, v45
  v_cvt_pk_bf16_f32 v247, v46, v47
  v_mfma_f32_16x16x32_bf16 v[16:19], a[84:87], a[108:111], v[16:19]
  buffer_store_dwordx4 v[244:247], v1, s[72:75], s46 offen offset:192 sc1 nt
  ds_read_b128 a[104:107], v3 offset:63488
  ds_read_b128 a[108:111], v3 offset:64512
  v_mfma_f32_16x16x32_bf16 v[16:19], a[88:91], a[112:115], v[16:19]
  ds_read_b128 a[112:115], v4 offset:0
  v_mfma_f32_16x16x32_bf16 v[16:19], a[92:95], a[116:119], v[16:19]
  ds_read_b128 a[116:119], v4 offset:1024
  v_mfma_f32_16x16x32_bf16 v[20:23], v[64:67], v[168:171], 0
  v_mfma_f32_16x16x32_bf16 v[20:23], v[68:71], v[172:175], v[20:23]
  s_nop 2
  v_mfma_f32_16x16x32_bf16 v[24:27], v[72:75], v[168:171], 0
  s_nop 2
  v_mfma_f32_16x16x32_bf16 v[24:27], v[76:79], v[172:175], v[24:27]
  s_waitcnt lgkmcnt(6)
  v_cvt_pk_bf16_f32 v248, v20, v21
  v_cvt_pk_bf16_f32 v249, v22, v23
  v_mfma_f32_16x16x32_bf16 v[28:31], a[0:3], a[120:123], 0
  v_cvt_pk_bf16_f32 v230, v16, v17
  v_cvt_pk_bf16_f32 v231, v18, v19
  v_mfma_f32_16x16x32_bf16 v[28:31], a[4:7], a[124:127], v[28:31]
  s_nop 0
  v_cvt_pk_bf16_f32 v250, v24, v25
  v_mfma_f32_16x16x32_bf16 v[28:31], a[8:11], a[128:131], v[28:31]
  v_cvt_pk_bf16_f32 v251, v26, v27
  v_mfma_f32_16x16x32_bf16 v[28:31], a[12:15], a[132:135], v[28:31]
  buffer_store_dwordx4 v[248:251], v1, s[12:15], s45 offen offset:192 sc1 nt
  v_mfma_f32_16x16x32_bf16 v[28:31], a[16:19], a[136:139], v[28:31]
  v_mfma_f32_16x16x32_bf16 v[28:31], a[20:23], a[140:143], v[28:31]
  v_mfma_f32_16x16x32_bf16 v[32:35], v[64:67], v[184:187], 0
  v_mfma_f32_16x16x32_bf16 v[32:35], v[68:71], v[188:191], v[32:35]
  s_nop 2
  v_mfma_f32_16x16x32_bf16 v[36:39], v[72:75], v[184:187], 0
  s_nop 2
  v_mfma_f32_16x16x32_bf16 v[36:39], v[76:79], v[188:191], v[36:39]
  v_cvt_pk_bf16_f32 v252, v32, v33
  v_cvt_pk_bf16_f32 v253, v34, v35
  v_mfma_f32_16x16x32_bf16 v[40:43], a[24:27], a[120:123], 0
  v_cvt_pk_bf16_f32 v232, v28, v29
  v_cvt_pk_bf16_f32 v233, v30, v31
  v_mfma_f32_16x16x32_bf16 v[40:43], a[28:31], a[124:127], v[40:43]
  s_nop 1
  v_cvt_pk_bf16_f32 v254, v36, v37
  v_mfma_f32_16x16x32_bf16 v[40:43], a[32:35], a[128:131], v[40:43]
  v_cvt_pk_bf16_f32 v255, v38, v39
  v_mfma_f32_16x16x32_bf16 v[40:43], a[36:39], a[132:135], v[40:43]
  buffer_store_dwordx4 v[252:255], v1, s[72:75], s47 offen offset:192 sc1 nt
  v_mfma_f32_16x16x32_bf16 v[40:43], a[40:43], a[136:139], v[40:43]
  v_mfma_f32_16x16x32_bf16 v[40:43], a[44:47], a[140:143], v[40:43]
  v_mfma_f32_16x16x32_bf16 v[44:47], a[48:51], a[120:123], 0
  v_mfma_f32_16x16x32_bf16 v[44:47], a[52:55], a[124:127], v[44:47]
  v_mfma_f32_16x16x32_bf16 v[44:47], a[56:59], a[128:131], v[44:47]
  v_mfma_f32_16x16x32_bf16 v[44:47], a[60:63], a[132:135], v[44:47]
  v_mfma_f32_16x16x32_bf16 v[44:47], a[64:67], a[136:139], v[44:47]
  v_mfma_f32_16x16x32_bf16 v[44:47], a[68:71], a[140:143], v[44:47]
  v_mfma_f32_16x16x32_bf16 v[16:19], a[72:75], a[120:123], 0
  ds_read_b128 a[120:123], v4 offset:2048
  v_cvt_pk_bf16_f32 v234, v40, v41
  v_mfma_f32_16x16x32_bf16 v[16:19], a[76:79], a[124:127], v[16:19]
  ds_read_b128 a[124:127], v4 offset:3072
  v_cvt_pk_bf16_f32 v235, v42, v43
  v_mfma_f32_16x16x32_bf16 v[16:19], a[80:83], a[128:131], v[16:19]
  ds_read_b128 a[128:131], v4 offset:4096
  v_cvt_pk_bf16_f32 v236, v44, v45
  v_mfma_f32_16x16x32_bf16 v[16:19], a[84:87], a[132:135], v[16:19]
  ds_read_b128 a[132:135], v4 offset:5120
  v_cvt_pk_bf16_f32 v237, v46, v47
  v_mfma_f32_16x16x32_bf16 v[16:19], a[88:91], a[136:139], v[16:19]
  ds_read_b128 a[136:139], v4 offset:6144
  v_mfma_f32_16x16x32_bf16 v[16:19], a[92:95], a[140:143], v[16:19]
  s_waitcnt lgkmcnt(5)
  ds_read_b128 a[140:143], v4 offset:7168
  v_mfma_f32_16x16x32_bf16 v[20:23], a[0:3], a[96:99], 0
  v_mfma_f32_16x16x32_bf16 v[20:23], a[4:7], a[100:103], v[20:23]
  v_mfma_f32_16x16x32_bf16 v[20:23], a[8:11], a[104:107], v[20:23]
  v_mfma_f32_16x16x32_bf16 v[20:23], a[12:15], a[108:111], v[20:23]
  v_mfma_f32_16x16x32_bf16 v[20:23], a[16:19], a[112:115], v[20:23]
  v_mfma_f32_16x16x32_bf16 v[20:23], a[20:23], a[116:119], v[20:23]
  v_cvt_pk_bf16_f32 v238, v16, v17
  v_cvt_pk_bf16_f32 v239, v18, v19
  v_mfma_f32_16x16x32_bf16 v[24:27], a[24:27], a[96:99], 0
  v_mfma_f32_16x16x32_bf16 v[24:27], a[28:31], a[100:103], v[24:27]
  v_mfma_f32_16x16x32_bf16 v[24:27], a[32:35], a[104:107], v[24:27]
  v_mfma_f32_16x16x32_bf16 v[24:27], a[36:39], a[108:111], v[24:27]
  v_mfma_f32_16x16x32_bf16 v[24:27], a[40:43], a[112:115], v[24:27]
  v_mfma_f32_16x16x32_bf16 v[24:27], a[44:47], a[116:119], v[24:27]
  v_cvt_pk_bf16_f32 v80, v20, v21
  v_cvt_pk_bf16_f32 v81, v22, v23
  v_mfma_f32_16x16x32_bf16 v[28:31], v[224:227], v[160:163], 0
  v_mfma_f32_16x16x32_bf16 v[28:31], v[228:231], v[164:167], v[28:31]
  s_nop 2
  v_mfma_f32_16x16x32_bf16 v[32:35], v[232:235], v[160:163], 0
  v_cvt_pk_bf16_f32 v82, v24, v25
  v_cvt_pk_bf16_f32 v83, v26, v27
  v_mfma_f32_16x16x32_bf16 v[32:35], v[236:239], v[164:167], v[32:35]
  s_nop 0
  v_cvt_pk_bf16_f32 v240, v28, v29
  v_mfma_f32_16x16x32_bf16 v[36:39], a[48:51], a[96:99], 0
  v_cvt_pk_bf16_f32 v241, v30, v31
  s_nop 0
  v_mfma_f32_16x16x32_bf16 v[36:39], a[52:55], a[100:103], v[36:39]
  s_nop 1
  v_cvt_pk_bf16_f32 v242, v32, v33
  v_mfma_f32_16x16x32_bf16 v[36:39], a[56:59], a[104:107], v[36:39]
  v_cvt_pk_bf16_f32 v243, v34, v35
  v_mfma_f32_16x16x32_bf16 v[36:39], a[60:63], a[108:111], v[36:39]
  buffer_store_dwordx4 v[240:243], v1, s[12:15], s44 offen offset:256 sc1 nt
  v_mfma_f32_16x16x32_bf16 v[36:39], a[64:67], a[112:115], v[36:39]
  v_mfma_f32_16x16x32_bf16 v[36:39], a[68:71], a[116:119], v[36:39]
  v_mfma_f32_16x16x32_bf16 v[40:43], v[224:227], v[176:179], 0
  v_mfma_f32_16x16x32_bf16 v[40:43], v[228:231], v[180:183], v[40:43]
  s_nop 2
  v_mfma_f32_16x16x32_bf16 v[44:47], v[232:235], v[176:179], 0
  s_nop 2
  v_mfma_f32_16x16x32_bf16 v[44:47], v[236:239], v[180:183], v[44:47]
  v_cvt_pk_bf16_f32 v244, v40, v41
  v_cvt_pk_bf16_f32 v245, v42, v43
  v_mfma_f32_16x16x32_bf16 v[16:19], a[72:75], a[96:99], 0
  v_cvt_pk_bf16_f32 v84, v36, v37
  v_cvt_pk_bf16_f32 v85, v38, v39
  v_mfma_f32_16x16x32_bf16 v[16:19], a[76:79], a[100:103], v[16:19]
  s_nop 1
  v_cvt_pk_bf16_f32 v246, v44, v45
  v_mfma_f32_16x16x32_bf16 v[16:19], a[80:83], a[104:107], v[16:19]
  v_cvt_pk_bf16_f32 v247, v46, v47
  v_mfma_f32_16x16x32_bf16 v[16:19], a[84:87], a[108:111], v[16:19]
  buffer_store_dwordx4 v[244:247], v1, s[72:75], s46 offen offset:256 sc1 nt
  v_mfma_f32_16x16x32_bf16 v[16:19], a[88:91], a[112:115], v[16:19]
  v_mfma_f32_16x16x32_bf16 v[16:19], a[92:95], a[116:119], v[16:19]
  v_mfma_f32_16x16x32_bf16 v[20:23], v[224:227], v[168:171], 0
  v_mfma_f32_16x16x32_bf16 v[20:23], v[228:231], v[172:175], v[20:23]
  s_nop 2
  v_mfma_f32_16x16x32_bf16 v[24:27], v[232:235], v[168:171], 0
  s_nop 2
  v_mfma_f32_16x16x32_bf16 v[24:27], v[236:239], v[172:175], v[24:27]
  s_waitcnt lgkmcnt(0)
  v_cvt_pk_bf16_f32 v248, v20, v21
  v_cvt_pk_bf16_f32 v249, v22, v23
  v_mfma_f32_16x16x32_bf16 v[28:31], a[0:3], a[120:123], 0
  v_cvt_pk_bf16_f32 v86, v16, v17
  v_cvt_pk_bf16_f32 v87, v18, v19
L_pad3:
  s_cbranch_execz L_padret
  v_mfma_f32_16x16x32_bf16 v[28:31], a[4:7], a[124:127], v[28:31]
  s_nop 0
  v_cvt_pk_bf16_f32 v250, v24, v25
  v_mfma_f32_16x16x32_bf16 v[28:31], a[8:11], a[128:131], v[28:31]
  v_cvt_pk_bf16_f32 v251, v26, v27
  v_mfma_f32_16x16x32_bf16 v[28:31], a[12:15], a[132:135], v[28:31]
  buffer_store_dwordx4 v[248:251], v1, s[12:15], s45 offen offset:256 sc1 nt
  v_mfma_f32_16x16x32_bf16 v[28:31], a[16:19], a[136:139], v[28:31]
  v_mfma_f32_16x16x32_bf16 v[28:31], a[20:23], a[140:143], v[28:31]
  v_mfma_f32_16x16x32_bf16 v[32:35], v[224:227], v[184:187], 0
  v_mfma_f32_16x16x32_bf16 v[32:35], v[228:231], v[188:191], v[32:35]
  s_nop 2
  v_mfma_f32_16x16x32_bf16 v[36:39], v[232:235], v[184:187], 0
  s_nop 2
  v_mfma_f32_16x16x32_bf16 v[36:39], v[236:239], v[188:191], v[36:39]
  v_cvt_pk_bf16_f32 v252, v32, v33
  v_cvt_pk_bf16_f32 v253, v34, v35
  v_mfma_f32_16x16x32_bf16 v[40:43], a[24:27], a[120:123], 0
  v_cvt_pk_bf16_f32 v88, v28, v29
  v_cvt_pk_bf16_f32 v89, v30, v31
  v_mfma_f32_16x16x32_bf16 v[40:43], a[28:31], a[124:127], v[40:43]
  s_nop 1
  v_cvt_pk_bf16_f32 v254, v36, v37
  v_mfma_f32_16x16x32_bf16 v[40:43], a[32:35], a[128:131], v[40:43]
  v_cvt_pk_bf16_f32 v255, v38, v39
  v_mfma_f32_16x16x32_bf16 v[40:43], a[36:39], a[132:135], v[40:43]
  buffer_store_dwordx4 v[252:255], v1, s[72:75], s47 offen offset:256 sc1 nt
  v_mfma_f32_16x16x32_bf16 v[40:43], a[40:43], a[136:139], v[40:43]
  v_mfma_f32_16x16x32_bf16 v[40:43], a[44:47], a[140:143], v[40:43]
  v_mfma_f32_16x16x32_bf16 v[44:47], a[48:51], a[120:123], 0
  v_mfma_f32_16x16x32_bf16 v[44:47], a[52:55], a[124:127], v[44:47]
  v_mfma_f32_16x16x32_bf16 v[44:47], a[56:59], a[128:131], v[44:47]
  v_mfma_f32_16x16x32_bf16 v[44:47], a[60:63], a[132:135], v[44:47]
  v_mfma_f32_16x16x32_bf16 v[44:47], a[64:67], a[136:139], v[44:47]
  v_mfma_f32_16x16x32_bf16 v[44:47], a[68:71], a[140:143], v[44:47]
  s_nop 1
  v_cvt_pk_bf16_f32 v90, v40, v41
  v_mfma_f32_16x16x32_bf16 v[16:19], a[72:75], a[120:123], 0
  v_cvt_pk_bf16_f32 v91, v42, v43
  s_nop 0
  v_mfma_f32_16x16x32_bf16 v[16:19], a[76:79], a[124:127], v[16:19]
  s_nop 0
  v_cvt_pk_bf16_f32 v92, v44, v45
  v_mfma_f32_16x16x32_bf16 v[16:19], a[80:83], a[128:131], v[16:19]
  v_cvt_pk_bf16_f32 v93, v46, v47
  v_mfma_f32_16x16x32_bf16 v[16:19], a[84:87], a[132:135], v[16:19]
  v_mfma_f32_16x16x32_bf16 v[16:19], a[88:91], a[136:139], v[16:19]
  v_mfma_f32_16x16x32_bf16 v[16:19], a[92:95], a[140:143], v[16:19]
  s_nop 2
  v_mfma_f32_16x16x32_bf16 v[20:23], v[80:83], v[160:163], 0
  s_nop 2
  v_mfma_f32_16x16x32_bf16 v[20:23], v[84:87], v[164:167], v[20:23]
  v_cvt_pk_bf16_f32 v94, v16, v17
  v_cvt_pk_bf16_f32 v95, v18, v19
  v_mfma_f32_16x16x32_bf16 v[24:27], v[88:91], v[160:163], 0
  s_nop 2
  v_mfma_f32_16x16x32_bf16 v[24:27], v[92:95], v[164:167], v[24:27]
  s_nop 0
  v_cvt_pk_bf16_f32 v240, v20, v21
  v_mfma_f32_16x16x32_bf16 v[28:31], v[80:83], v[168:171], 0
  v_cvt_pk_bf16_f32 v241, v22, v23
  s_nop 0
  v_mfma_f32_16x16x32_bf16 v[28:31], v[84:87], v[172:175], v[28:31]
  s_nop 1
  v_cvt_pk_bf16_f32 v242, v24, v25
  v_mfma_f32_16x16x32_bf16 v[32:35], v[88:91], v[168:171], 0
  v_cvt_pk_bf16_f32 v243, v26, v27
  s_nop 0
  v_mfma_f32_16x16x32_bf16 v[32:35], v[92:95], v[172:175], v[32:35]
  buffer_store_dwordx4 v[240:243], v1, s[12:15], s44 offen offset:320 sc1 nt
  v_cvt_pk_bf16_f32 v244, v28, v29
  v_cvt_pk_bf16_f32 v245, v30, v31
  v_mfma_f32_16x16x32_bf16 v[36:39], v[80:83], v[176:179], 0
  s_nop 2
  v_mfma_f32_16x16x32_bf16 v[36:39], v[84:87], v[180:183], v[36:39]
  v_cvt_pk_bf16_f32 v246, v32, v33
  v_cvt_pk_bf16_f32 v247, v34, v35
  v_mfma_f32_16x16x32_bf16 v[40:43], v[88:91], v[176:179], 0
  s_nop 2
  v_mfma_f32_16x16x32_bf16 v[40:43], v[92:95], v[180:183], v[40:43]
  s_nop 0
  v_cvt_pk_bf16_f32 v248, v36, v37
  v_mfma_f32_16x16x32_bf16 v[44:47], v[80:83], v[184:187], 0
  v_cvt_pk_bf16_f32 v249, v38, v39
  s_nop 0
  v_mfma_f32_16x16x32_bf16 v[44:47], v[84:87], v[188:191], v[44:47]
  buffer_store_dwordx4 v[244:247], v1, s[12:15], s45 offen offset:320 sc1 nt
  s_nop 0
  v_cvt_pk_bf16_f32 v250, v40, v41
  v_mfma_f32_16x16x32_bf16 v[16:19], v[88:91], v[184:187], 0
  v_cvt_pk_bf16_f32 v251, v42, v43
  s_nop 0
  v_mfma_f32_16x16x32_bf16 v[16:19], v[92:95], v[188:191], v[16:19]
  s_nop 0
  v_cvt_pk_bf16_f32 v252, v44, v45
  v_cvt_pk_bf16_f32 v253, v46, v47
  buffer_store_dwordx4 v[248:251], v1, s[72:75], s46 offen offset:320 sc1 nt
  s_nop 0
  s_nop 0
  s_nop 0
  s_nop 0
  v_cvt_pk_bf16_f32 v254, v16, v17
  v_cvt_pk_bf16_f32 v255, v18, v19
  buffer_store_dwordx4 v[252:255], v1, s[72:75], s47 offen offset:320 sc1 nt
  s_endpgm
.p2align 6
L_loader:
  s_barrier
  buffer_load_dwordx2 v[14:15], off, s[36:39], 0 sc1
  buffer_load_dwordx2 v[12:13], v2, s[16:19], s93 offen sc1
  buffer_load_dword v29, v28, s[16:19], s3 offen sc1
  s_waitcnt vmcnt(1)
  s_branch L_eval
L_pollA:
  buffer_load_dwordx2 v[14:15], off, s[36:39], 0 sc1
  buffer_load_dwordx2 v[12:13], v2, s[16:19], s93 offen sc1
  s_add_u32 s92, s92, 1
  s_cmp_gt_u32 s92, 200000
  s_cbranch_scc1 L_pollA_x
L_pollA_0:
  s_waitcnt vmcnt(0)
L_eval:
  v_cmp_ne_u64 vcc, v[12:13], v[14:15]
  v_cmp_eq_u32 s[26:27], 0, v14
  s_nop 1
  s_or_b64 vcc, vcc, s[26:27]
  s_and_b32 s26, vcc_lo, 0x3f
  s_cbranch_scc1 L_pollA
L_pollA_x:
  s_mov_b32 m0, 90112
  s_nop 0
L_fill1:
  buffer_load_dwordx4 v3, s[16:19], m0 offen offset:0 sc1 lds
  buffer_load_dwordx4 v3, s[16:19], m0 offen offset:1024 sc1 lds
  buffer_load_dwordx4 v3, s[16:19], m0 offen offset:2048 sc1 lds
  s_add_u32 m0, m0, 3072
  s_cmp_lt_u32 m0, 102400
  s_cbranch_scc1 L_fill1
  s_cmp_eq_u64 vcc, 0
  s_cbranch_scc1 L_pollB_x
L_pollB:
L_pollB_0:
  buffer_load_dwordx2 v[12:13], v2, s[16:19], s93 offen sc1
  s_add_u32 s92, s92, 1
  s_cmp_gt_u32 s92, 200000
  s_cbranch_scc1 L_pollB_x
  s_waitcnt vmcnt(0)
  v_cmp_ne_u64 vcc, v[12:13], v[14:15]
  s_cbranch_vccnz L_pollB
L_pollB_x:
  s_mov_b32 m0, 102400
  s_nop 0
L_fill2:
  buffer_load_dwordx4 v3, s[16:19], m0 offen offset:0 sc1 lds
  buffer_load_dwordx4 v3, s[16:19], m0 offen offset:1024 sc1 lds
  buffer_load_dwordx4 v3, s[16:19], m0 offen offset:2048 sc1 lds
  s_add_u32 m0, m0, 3072
  s_cmp_lt_u32 m0, 126976
  s_cbranch_scc1 L_fill2
  s_waitcnt vmcnt(24) lgkmcnt(0)
  s_barrier
  s_mov_b32 m0, 126976
  s_nop 0
L_fill3:
  buffer_load_dwordx4 v3, s[16:19], m0 offen offset:0 sc1 lds
  buffer_load_dwordx4 v3, s[16:19], m0 offen offset:1024 sc1 lds
  buffer_load_dwordx4 v3, s[16:19], m0 offen offset:2048 sc1 lds
  s_add_u32 m0, m0, 3072
  s_cmp_lt_u32 m0, 139264
  s_cbranch_scc1 L_fill3
  s_waitcnt vmcnt(24)
  s_barrier
  s_mov_b32 m0, 139264
  s_nop 0
L_fill4:
  buffer_load_dwordx4 v3, s[16:19], m0 offen offset:0 sc1 lds
  buffer_load_dwordx4 v3, s[16:19], m0 offen offset:1024 sc1 lds
  buffer_load_dwordx4 v3, s[16:19], m0 offen offset:2048 sc1 lds
  s_add_u32 m0, m0, 3072
  s_cmp_lt_u32 m0, 163840
  s_cbranch_scc1 L_fill4
  buffer_load_dwordx2 v[12:13], v2, s[16:19], s94 offen sc1
  buffer_load_dword v29, v28, s[16:19], 0 offen sc1
  s_waitcnt vmcnt(38)
  s_barrier
  s_cmp_lt_u32 s2, 224
  s_cbranch_scc1 L_nox
  ds_read_b128 a[48:51], v252 offset:0
  ds_read_b128 a[52:55], v253 offset:0
  ds_read_b128 a[56:59], v252 offset:128
  ds_read_b128 a[60:63], v253 offset:128
  ds_read_b128 a[64:67], v252 offset:256
  ds_read_b128 a[68:71], v253 offset:256
  ds_read_b128 a[72:75], v252 offset:6144
  ds_read_b128 a[76:79], v253 offset:6144
  ds_read_b128 a[80:83], v252 offset:6272
  ds_read_b128 a[84:87], v253 offset:6272
  ds_read_b128 a[88:91], v252 offset:6400
  ds_read_b128 a[92:95], v253 offset:6400
  s_waitcnt vmcnt(26) lgkmcnt(0)
  s_barrier
  s_add_u32 m0, s24, 0
  s_mov_b32 s25, s44
  buffer_load_dwordx4 v240, s[8:11], s25 offen offset:0 nt lds
  buffer_load_dwordx4 v242, s[8:11], s25 offen offset:1024 nt lds
  buffer_load_dwordx4 v244, s[8:11], s25 offen offset:2048 nt lds
  s_add_u32 m0, s24, 3072
  s_add_u32 s25, s25, 86016
  buffer_load_dwordx4 v241, s[8:11], s25 offen offset:0 nt lds
  buffer_load_dwordx4 v243, s[8:11], s25 offen offset:1024 nt lds
  buffer_load_dwordx4 v245, s[8:11], s25 offen offset:2048 nt lds
  s_add_u32 m0, s24, 6144
  s_add_u32 s25, s25, 86016
  buffer_load_dwordx4 v240, s[8:11], s25 offen offset:0 nt lds
  buffer_load_dwordx4 v242, s[8:11], s25 offen offset:1024 nt lds
  buffer_load_dwordx4 v244, s[8:11], s25 offen offset:2048 nt lds
  s_add_u32 m0, s24, 9216
  s_add_u32 s25, s25, 86016
  buffer_load_dwordx4 v241, s[8:11], s25 offen offset:0 nt lds
  buffer_load_dwordx4 v243, s[8:11], s25 offen offset:1024 nt lds
  buffer_load_dwordx4 v245, s[8:11], s25 offen offset:2048 nt lds
  s_waitcnt vmcnt(13)
  s_branch L_nox2
L_nox:
  s_waitcnt vmcnt(26)
  s_barrier
  s_waitcnt vmcnt(1)
L_nox2:
  v_cmp_ne_u64 vcc, v[12:13], v[14:15]
  s_cbranch_vccz L_pollN_x
L_pollN:
L_pollN_0:
  buffer_load_dwordx2 v[12:13], v2, s[16:19], s94 offen sc1
  s_add_u32 s92, s92, 1
  s_cmp_gt_u32 s92, 200000
  s_cbranch_scc1 L_pollN_x
  s_waitcnt vmcnt(0)
  v_cmp_ne_u64 vcc, v[12:13], v[14:15]
  s_cbranch_vccnz L_pollN
L_pollN_x:
  s_barrier
  s_cmp_ge_u32 s2, 224
  s_cbranch_scc1 L_late
  s_cmp_lg_u32 s2, 0
  s_cbranch_scc1 L_noep
  s_mov_b64 exec, 1
  buffer_store_dwordx2 v[6:7], off, s[16:19], s95 sc1
  s_mov_b64 exec, -1
L_noep:
L_end:
  s_endpgm
L_late:
  ds_read_b128 a[96:99], v4 offset:24576
  ds_read_b128 a[100:103], v4 offset:25600
  ds_read_b128 a[104:107], v4 offset:26624
  ds_read_b128 a[108:111], v4 offset:27648
  ds_read_b128 a[112:115], v4 offset:28672
  ds_read_b128 a[116:119], v4 offset:29696
  ds_read_b128 a[120:123], v4 offset:30720
  ds_read_b128 a[124:127], v4 offset:31744
  ds_read_b128 a[128:131], v4 offset:32768
  ds_read_b128 a[132:135], v4 offset:33792
  ds_read_b128 a[136:139], v4 offset:34816
  ds_read_b128 a[140:143], v4 offset:35840
  s_waitcnt vmcnt(0) lgkmcnt(0)
  ds_read_b128 a[0:3], v252 offset:0
  ds_read_b128 a[4:7], v253 offset:0
  ds_read_b128 a[8:11], v252 offset:128
  ds_read_b128 a[12:15], v253 offset:128
  ds_read_b128 a[16:19], v252 offset:256
  ds_read_b128 a[20:23], v253 offset:256
  ds_read_b128 a[24:27], v252 offset:6144
  ds_read_b128 a[28:31], v253 offset:6144
  ds_read_b128 a[32:35], v252 offset:6272
  ds_read_b128 a[36:39], v253 offset:6272
  ds_read_b128 a[40:43], v252 offset:6400
  ds_read_b128 a[44:47], v253 offset:6400
  s_waitcnt lgkmcnt(0)
  s_branch L_join
L_last:
  s_endpgm
.section .rodata,"a"
.p2align 6
.amdhsa_kernel standalone__swin_window_attn__vision_kernel
  .amdhsa_next_free_vgpr 400
  .amdhsa_next_free_sgpr 96
  .amdhsa_accum_offset 256
  .amdhsa_group_segment_fixed_size 0
  .amdhsa_kernarg_size 48
  .amdhsa_user_sgpr_count 2
  .amdhsa_user_sgpr_kernarg_segment_ptr 1
  .amdhsa_system_sgpr_workgroup_id_x 1
.end_amdhsa_kernel
```
